```python
import torch

def _softmax(x, axis=-1):
    return torch.softmax(x, dim=axis)
def _gelu(x):
    return torch.nn.functional.gelu(x, approximate="tanh")
def _silu(x):
    return torch.nn.functional.silu(x)
def _sigmoid(x):
    return torch.sigmoid(x)
def _layernorm(x, axis=-1, eps=1e-5):
    m = x.mean(dim=axis, keepdim=True)
    v = x.var(dim=axis, keepdim=True, unbiased=False)
    return (x - m) / torch.sqrt(v + eps)
def _scatter_add(tgt, idx, src, axis=0):
    return tgt.clone().index_add_(axis, idx, src)
def _segment_sum(src, seg, n):
    out = torch.zeros((n,) + src.shape[1:], dtype=src.dtype)
    return out.index_add_(0, seg, src)
def _pad(x, pw):
    flat = tuple(v for pair in reversed(pw) for v in pair)
    return torch.nn.functional.pad(x, flat)

kernel_name = 'recurrent_scan__spectral_fnet__mixer_channel_mlp__prompt'

def setup_inputs():

    _w = (lambda a: (lambda t: t.to(torch.bfloat16) if t.is_floating_point() else t)(torch.as_tensor(a)))
    def _A_setup():
        B, S, D = 1, 2048, 512
        ns = torch.arange(S)[:, None] * torch.arange(S)[None, :]
        nd = torch.arange(D)[:, None] * torch.arange(D)[None, :]
        Ws_re = torch.cos(-2.0 * torch.pi * ns / S).to(float)
        Ws_im = torch.sin(-2.0 * torch.pi * ns / S).to(float)
        Wd_re = torch.cos(-2.0 * torch.pi * nd / D).to(float)
        Wd_im = torch.sin(-2.0 * torch.pi * nd / D).to(float)
        return {
            "x": _w((lambda *s: torch.randn(*s, dtype=torch.bfloat16) * 0.05)(B, S, D)),
            "dft_seq_re": _w(Ws_re),
            "dft_seq_im": _w(Ws_im),
            "dft_hid_re": _w(Wd_re),
            "dft_hid_im": _w(Wd_im),
        }
    _A_in = _A_setup()

    def _B_setup():
        B, S, D, F = 1, 2048, 512, 1376
        return {
            "x": _w((lambda *s: torch.randn(*s, dtype=torch.bfloat16) * 0.05)(B, S, D)),
            "w1": _w((lambda *s: torch.randn(*s, dtype=torch.bfloat16) * 0.8)(D, F) * (D ** -0.5)),
            "b1": _w((lambda *s: torch.randn(*s, dtype=torch.bfloat16) * 0.8)(F)),
            "w2": _w((lambda *s: torch.randn(*s, dtype=torch.bfloat16) * 0.05)(F, D) * (F ** -0.5)),
            "b2": _w((lambda *s: torch.randn(*s, dtype=torch.bfloat16) * 0.05)(D)),
        }
    _B_in = _B_setup()

    return {
        "A_x": _A_in["x"],
        "A_dft_seq_re": _A_in["dft_seq_re"],
        "A_dft_seq_im": _A_in["dft_seq_im"],
        "A_dft_hid_re": _A_in["dft_hid_re"],
        "A_dft_hid_im": _A_in["dft_hid_im"],
        "B_x": _B_in["x"],
        "B_w1": _B_in["w1"],
        "B_b1": _B_in["b1"],
        "B_w2": _B_in["w2"],
        "B_b2": _B_in["b2"],
    }

def reference(A_x, A_dft_seq_re, A_dft_seq_im, A_dft_hid_re, A_dft_hid_im, B_x, B_w1, B_b1, B_w2, B_b2):
    def _A_ref(x, dft_seq_re, dft_seq_im, dft_hid_re, dft_hid_im):
        a = torch.einsum("bsd,ed->bse", x, dft_hid_re)
        b = torch.einsum("bsd,ed->bse", x, dft_hid_im)
        y = torch.einsum("ts,bse->bte", dft_seq_re, a) - torch.einsum("ts,bse->bte", dft_seq_im, b)
        return y

    def _B_ref(x, w1, b1, w2, b2):
        y = _layernorm(x, axis=-1)
        h = _gelu(torch.einsum("bsd,df->bsf", y, w1) + b1)
        return torch.einsum("bsf,fd->bsd", h, w2) + b2

    x = A_x
    xn = _layernorm(x, axis=-1)
    s = _A_ref(xn, A_dft_seq_re, A_dft_seq_im, A_dft_hid_re, A_dft_hid_im)
    g = _silu(_B_ref(xn, B_w1, B_b1, B_w2, B_b2))
    return x + s * g
```

```asm
; @launch kernel=recurrent_scan__spectral_fnet__mixer_channel_mlp__prompt_kernel grid=(256,1,1) block=(512,1,1) lds=162880
.amdgcn_target "amdgcn-amd-amdhsa--gfx950"
.text
    .globl recurrent_scan__spectral_fnet__mixer_channel_mlp__prompt_kernel
    .p2align 8
    .type recurrent_scan__spectral_fnet__mixer_channel_mlp__prompt_kernel,@function
recurrent_scan__spectral_fnet__mixer_channel_mlp__prompt_kernel:
    s_cmp_ge_u32 s2, 256
    s_cbranch_scc1 L_k1_done
    s_load_dwordx2 s[4:5], s[0:1], 96
    s_load_dwordx2 s[62:63], s[0:1], 0
    s_load_dwordx4 s[44:47], s[0:1], 24
    s_load_dwordx4 s[48:51], s[0:1], 48
    s_load_dwordx2 s[6:7], s[0:1], 64
    s_load_dwordx2 s[64:65], s[0:1], 88
    s_memrealtime s[94:95]
    s_cmp_ge_u32 s2, 40
    s_cbranch_scc1 L_cpf
    v_subrev_u32 v157, 64, v0
    v_cmp_gt_u32 vcc, 64, v157
    s_cbranch_vccz L_cpf
    s_getpc_b64 s[86:87]
L_cpc:
    s_sub_u32 s86, s86, L_cpc-recurrent_scan__spectral_fnet__mixer_channel_mlp__prompt_kernel
    s_subb_u32 s87, s87, 0
    s_lshr_b32 s22, s2, 3
    s_mul_i32 s22, s22, 8192
    v_lshl_add_u32 v157, v157, 7, s22
    v_min_u32 v157, L_k1_done-recurrent_scan__spectral_fnet__mixer_channel_mlp__prompt_kernel, v157
    global_load_dword v157, v157, s[86:87]
L_cpf:
    v_lshrrev_b32 v1, 6, v0
    s_nop 0
    v_readfirstlane_b32 s54, v1
    s_nop 3
    s_lshr_b32 s53, s54, 2
    s_and_b32 s16, s54, 3
    s_and_b32 s28, s2, 7
    s_lshr_b32 s29, s2, 3
    v_lshlrev_b32 v1, 2, v0
    v_mov_b32 v4, 0
    v_cmp_gt_u32 vcc, 16, v0
    s_and_saveexec_b64 s[22:23], vcc
    v_add_u32 v1, 162560, v1
    ds_write_b32 v1, v4
    s_mov_b64 exec, -1
    s_waitcnt lgkmcnt(0)
    s_mov_b32 s8, s62
    s_mov_b32 s9, s63
    s_mov_b32 s10, 2097152
    s_mov_b32 s11, 0x20000
    s_mov_b32 s24, s4
    s_mov_b32 s25, s5
    s_mov_b32 s26, 67108864
    s_mov_b32 s27, 0x20000
    s_mov_b32 s66, 256
    s_mov_b32 s67, 0x20000
    s_cmp_lg_u32 s54, 0
    s_cbranch_scc1 L_k1_nz
    s_cmp_lg_u32 s2, 0
    s_cbranch_scc1 L_k1_nz
    s_or_b32 s22, s94, 1
    v_mov_b32 v5, s22
    s_mov_b64 exec, 1
    buffer_store_dword v5, v4, s[64:67], 0 offen sc1
    s_mov_b64 exec, -1
L_k1_nz:
    s_cmp_lt_u32 s29, 22
    s_cbranch_scc1 L_k1_typeB
    s_cmp_ge_u32 s29, 30
    s_cbranch_scc1 L_k1_spare
    s_sub_u32 s29, s29, 22
    s_and_b32 s30, s28, 1
    s_lshl_b32 s30, s30, 1
    s_and_b32 s23, s29, 1
    s_lshr_b32 s22, s29, 1
    s_add_u32 s29, s30, s23
    s_lshr_b32 s28, s28, 1
    s_lshl_b32 s28, s28, 2
    s_add_u32 s28, s28, s22
    s_cmp_ge_u32 s29, 2
    s_cselect_b32 s12, s46, s44
    s_cselect_b32 s13, s47, s45
    s_mov_b32 s14, 524288
    s_mov_b32 s15, 0x20000
    s_and_b32 s18, s29, 1
    s_lshl_b32 s18, s18, 17
    v_and_b32 v1, 15, v0
    v_cmp_eq_u32 s[68:69], 0, v1
    s_and_b32 s23, s16, 1
    s_lshl_b32 s23, s23, 2
    s_add_u32 s23, s23, s29
    s_cmp_eq_u32 s23, 2
    s_cselect_b32 s68, s68, 0
    s_cselect_b32 s69, s69, 0
    v_mov_b32 v15, 0xbf803f80
    s_and_b32 s55, s29, 1
    s_lshl_b32 s55, s55, 7
    s_and_b32 s23, s16, 1
    s_lshl_b32 s23, s23, 6
    s_add_u32 s55, s55, s23
    s_lshr_b32 s23, s28, 3
    s_lshl_b32 s23, s23, 5
    s_add_u32 s55, s55, s23
    s_lshr_b32 s23, s29, 1
    s_lshl_b32 s23, s23, 4
    s_add_u32 s55, s55, s23
    s_and_b32 s23, s28, 7
    s_lshl_b32 s23, s23, 1
    s_add_u32 s55, s55, s23
    s_lshr_b32 s23, s16, 1
    s_add_u32 s55, s55, s23
    s_lshl_b32 s55, s55, 2
    s_add_u32 s55, s55, 15794176
    s_cmp_eq_u32 s53, 0
    s_cbranch_scc1 L_k1a_cons
    s_setprio 1
    v_and_b32 v1, 63, v0
    v_lshrrev_b32 v2, 3, v1
    v_lshrrev_b32 v3, 4, v1
    v_and_b32 v4, 7, v1
    v_xor_b32 v8, v3, v4
    s_and_b32 s22, s16, 1
    s_lshl_b32 s22, s22, 2
    v_xor_b32 v8, s22, v8
    v_lshlrev_b32 v8, 4, v8
    s_lshr_b32 s22, s2, 3
    s_add_u32 s22, s22, 0
    s_and_b32 s56, s22, 7
    s_lshl_b32 s17, s56, 7
    s_mul_i32 s23, s56, 128
    s_add_u32 s18, s18, s23
    s_lshl_b32 s19, s16, 10
    v_lshl_add_u32 v10, v2, 10, v8
    s_lshl_b32 s22, s16, 13
    s_add_u32 s18, s18, s22
    s_add_u32 m0, s19, 16384
    s_add_u32 s22, s18, 0
    buffer_load_dwordx4 v10, s[12:15], s22 offen lds
    s_add_u32 m0, s19, 20480
    s_add_u32 s22, s18, 32768
    buffer_load_dwordx4 v10, s[12:15], s22 offen lds
    s_add_u32 m0, s19, 24576
    s_add_u32 s22, s18, 65536
    buffer_load_dwordx4 v10, s[12:15], s22 offen lds
    s_add_u32 m0, s19, 28672
    s_add_u32 s22, s18, 98304
    buffer_load_dwordx4 v10, s[12:15], s22 offen lds
    v_lshrrev_b32 v5, 5, v1
    v_and_b32 v6, 3, v2
    v_lshl_add_u32 v5, v5, 3, v6
    s_and_b32 s22, s16, 1
    s_lshl_b32 s22, s22, 4
    s_lshl_b32 s23, s28, 5
    s_add_u32 s22, s22, s23
    v_add_u32 v5, s22, v5
    v_cmp_eq_u32 vcc, 0, v5
    s_cmp_lt_u32 s16, 2
    s_cselect_b32 s23, 1, -1
    s_cselect_b32 s31, 0, 2048
    s_cselect_b32 s32, 0, 512
    s_sub_u32 s33, 0, s23
    v_mov_b32 v6, s31
    v_mad_i32_i24 v6, v5, s23, v6
    v_mov_b32 v7, 1024
    v_mad_i32_i24 v7, v5, s33, v7
    s_lshl_b32 s23, s23, 12
    v_lshl_add_u32 v15, v6, 10, v8
    v_lshl_add_u32 v16, v7, 10, v8
    v_add_u32 v15, s23, v15
    v_subrev_u32 v16, s23, v16
    v_mov_b32 v4, s32
    v_cndmask_b32 v6, v6, v4, vcc
    v_add_u32 v4, 1024, v4
    v_cndmask_b32 v7, v7, v4, vcc
    v_lshl_add_u32 v13, v6, 10, v8
    v_lshl_add_u32 v14, v7, 10, v8
    s_add_u32 m0, s19, 0
    s_nop 0
    buffer_load_dwordx4 v13, s[8:11], s17 offen lds
    s_add_u32 m0, s19, 4096
    s_nop 0
    buffer_load_dwordx4 v14, s[8:11], s17 offen lds
    s_add_u32 m0, s19, 8192
    s_nop 0
    buffer_load_dwordx4 v15, s[8:11], s17 offen lds
    s_add_u32 m0, s19, 12288
    s_nop 0
    buffer_load_dwordx4 v16, s[8:11], s17 offen lds
    s_add_u32 s17, s17, 128
    s_add_u32 s18, s18, 128
    s_cmp_eq_u32 s17, 1024
    s_cselect_b32 s17, 0, s17
    s_cselect_b32 s22, 1024, 0
    s_sub_u32 s18, s18, s22
    s_and_b32 s40, s2, 6
    s_sub_u32 s41, 12, s40
    s_cmp_lt_u32 s2, 128
    s_cselect_b32 s40, s40, s41
    s_lshr_b32 s41, s2, 6
    s_add_u32 s40, s40, s41
    s_lshl_b32 s40, s40, 1
    s_and_b32 s41, s2, 1
    s_add_u32 s40, s40, s41
    s_lshl_b32 s40, s40, 3
    s_bfe_u32 s41, s2, 0x30003
    s_add_u32 s40, s40, s41
    s_lshl_b32 s40, s40, 2
    s_add_u32 s40, s40, s16
    s_sub_u32 s41, 2048, s40
    s_cmp_eq_u32 s40, 0
    s_cselect_b32 s41, 1024, s41
    v_lshlrev_b32 v240, 4, v1
    s_lshl_b32 s22, s40, 10
    s_lshl_b32 s23, s41, 10
    buffer_load_dwordx4 v[216:219], v240, s[8:11], s22 offen
    buffer_load_dwordx4 v[220:223], v240, s[8:11], s23 offen
    s_add_u32 m0, s19, 49152
    s_add_u32 s22, s18, 0
    buffer_load_dwordx4 v10, s[12:15], s22 offen lds
    s_add_u32 m0, s19, 53248
    s_add_u32 s22, s18, 32768
    buffer_load_dwordx4 v10, s[12:15], s22 offen lds
    s_add_u32 m0, s19, 57344
    s_add_u32 s22, s18, 65536
    buffer_load_dwordx4 v10, s[12:15], s22 offen lds
    s_add_u32 m0, s19, 61440
    s_add_u32 s22, s18, 98304
    buffer_load_dwordx4 v10, s[12:15], s22 offen lds
    s_add_u32 m0, s19, 32768
    s_nop 0
    buffer_load_dwordx4 v13, s[8:11], s17 offen lds
    s_add_u32 m0, s19, 36864
    s_nop 0
    buffer_load_dwordx4 v14, s[8:11], s17 offen lds
    s_add_u32 m0, s19, 40960
    s_nop 0
    buffer_load_dwordx4 v15, s[8:11], s17 offen lds
    s_add_u32 m0, s19, 45056
    s_nop 0
    buffer_load_dwordx4 v16, s[8:11], s17 offen lds
    s_add_u32 s17, s17, 128
    s_add_u32 s18, s18, 128
    s_cmp_eq_u32 s17, 1024
    s_cselect_b32 s17, 0, s17
    s_cselect_b32 s22, 1024, 0
    s_sub_u32 s18, s18, s22
    v_mov_b32 v236, 0
    buffer_load_dword v236, v236, s[64:67], 0 offen sc1
    s_bfe_u32 s20, s2, 0x10001
    s_lshl_b32 s23, s20, 15
    s_add_u32 s23, s23, s19
    v_add_u32 v238, s23, v240
    s_add_u32 s21, s29, 11
    s_bfe_u32 s22, s2, 0x10002
    s_lshl_b32 s22, s22, 4
    s_add_u32 s21, s21, s22
    s_lshl_b32 s21, s21, 13
    s_add_u32 s21, s21, 15204352
    s_add_u32 s20, s20, s56
    s_and_b32 s20, s20, 7
    s_lshl_b32 s20, s20, 10
    s_add_u32 s20, s20, s21
    v_and_b32 v4, 3, v1
    v_mov_b32 v237, v13
    v_cmp_eq_u32 vcc, 1, v4
    s_nop 1
    v_cndmask_b32 v237, v237, v14, vcc
    v_cmp_eq_u32 vcc, 2, v4
    s_nop 1
    v_cndmask_b32 v237, v237, v15, vcc
    v_cmp_eq_u32 vcc, 3, v4
    s_nop 1
    v_cndmask_b32 v237, v237, v16, vcc
    v_lshrrev_b32 v237, 10, v237
    v_lshlrev_b32 v237, 4, v237
    v_add_u32 v237, 14745600, v237
    v_and_b32 v4, 7, v1
    v_lshlrev_b32 v4, 5, v4
    v_lshl_add_u32 v4, v2, 10, v4
    s_lshl_b32 s22, s16, 8
    v_add_u32 v239, s22, v4
    s_waitcnt vmcnt(11)
    s_barrier
    s_add_u32 m0, s19, 81920
    s_add_u32 s22, s18, 0
    buffer_load_dwordx4 v10, s[12:15], s22 offen lds
    s_add_u32 m0, s19, 86016
    s_add_u32 s22, s18, 32768
    buffer_load_dwordx4 v10, s[12:15], s22 offen lds
    s_add_u32 m0, s19, 90112
    s_add_u32 s22, s18, 65536
    buffer_load_dwordx4 v10, s[12:15], s22 offen lds
    s_add_u32 m0, s19, 94208
    s_add_u32 s22, s18, 98304
    buffer_load_dwordx4 v10, s[12:15], s22 offen lds
    s_add_u32 m0, s19, 65536
    s_nop 0
    buffer_load_dwordx4 v13, s[8:11], s17 offen lds
    s_add_u32 m0, s19, 69632
    s_nop 0
    buffer_load_dwordx4 v14, s[8:11], s17 offen lds
    s_add_u32 m0, s19, 73728
    s_nop 0
    buffer_load_dwordx4 v15, s[8:11], s17 offen lds
    s_add_u32 m0, s19, 77824
    s_nop 0
    buffer_load_dwordx4 v16, s[8:11], s17 offen lds
    s_add_u32 s17, s17, 128
    s_add_u32 s18, s18, 128
    s_cmp_eq_u32 s17, 1024
    s_cselect_b32 s17, 0, s17
    s_cselect_b32 s22, 1024, 0
    s_sub_u32 s18, s18, s22
    s_waitcnt vmcnt(17)
    s_mov_b32 s42, 0x3f803f80
    v_mov_b32 v242, 0
    v_mov_b32 v243, 0
    v_mov_b32 v244, 0
    v_mov_b32 v245, 0
    v_dot2c_f32_bf16 v242, s42, v216
    v_dot2c_f32_bf16 v244, v216, v216
    v_dot2c_f32_bf16 v243, s42, v220
    v_dot2c_f32_bf16 v245, v220, v220
    v_dot2c_f32_bf16 v242, s42, v217
    v_dot2c_f32_bf16 v244, v217, v217
    v_dot2c_f32_bf16 v243, s42, v221
    v_dot2c_f32_bf16 v245, v221, v221
    v_dot2c_f32_bf16 v242, s42, v218
    v_dot2c_f32_bf16 v244, v218, v218
    v_dot2c_f32_bf16 v243, s42, v222
    v_dot2c_f32_bf16 v245, v222, v222
    v_dot2c_f32_bf16 v242, s42, v219
    v_dot2c_f32_bf16 v244, v219, v219
    v_dot2c_f32_bf16 v243, s42, v223
    v_dot2c_f32_bf16 v245, v223, v223
    v_mov_b32 v249, s41
    v_mov_b32 v248, s40
    v_cmp_gt_u32 vcc, 32, v1
    v_permlane32_swap_b32 v242, v243
    v_permlane32_swap_b32 v244, v245
    v_cndmask_b32 v249, v249, v248, vcc
    v_add_f32 v242, v242, v243
    v_add_f32 v244, v244, v245
    v_lshlrev_b32 v249, 4, v249
    s_nop 0
    v_permlane16_swap_b32 v242, v244
    s_nop 0
    v_add_f32 v242, v242, v244
    s_nop 1
    v_add_f32_dpp v242, v242, v242 row_ror:8 row_mask:0xf bank_mask:0xf
    s_nop 1
    v_add_f32_dpp v242, v242, v242 row_ror:4 row_mask:0xf bank_mask:0xf
    s_nop 1
    v_add_f32_dpp v242, v242, v242 row_ror:2 row_mask:0xf bank_mask:0xf
    s_nop 1
    v_add_f32_dpp v242, v242, v242 row_ror:1 row_mask:0xf bank_mask:0xf
    v_mov_b32 v243, v242
    s_nop 1
    v_permlane16_swap_b32 v242, v243
    s_nop 0
    v_mul_f32 v242, 0x3b000000, v242
    v_mul_f32 v243, 0x3b000000, v243
    v_fma_f32 v243, -v242, v242, v243
    v_max_f32 v243, 0, v243
    v_mov_b32 v245, v243
    v_cvt_pk_bf16_f32 v245, v245, v245
    v_lshlrev_b32 v245, 16, v245
    v_add_f32 v245, 0x3727c5ac, v245
    v_cvt_pk_bf16_f32 v245, v245, v245
    v_lshlrev_b32 v245, 16, v245
    v_sqrt_f32 v245, v245
    s_nop 0
    v_cvt_pk_bf16_f32 v218, v242, v245
    v_lshlrev_b32 v244, 16, v218
    v_and_b32 v245, 0xffff0000, v218
    v_rcp_f32 v245, v245
    v_sub_f32 v246, v242, v244
    v_mul_f32 v246, v246, v245
    v_cvt_pk_bf16_f32 v246, v246, v246
    v_lshlrev_b32 v246, 16, v246
    v_mul_f32 v243, v243, v245
    v_mul_f32 v243, v243, v245
    v_cvt_pk_bf16_f32 v243, v243, v243
    v_lshlrev_b32 v243, 16, v243
    v_add_f32 v243, 0x3727c5ac, v243
    v_cvt_pk_bf16_f32 v243, v243, v243
    v_lshlrev_b32 v243, 16, v243
    v_sqrt_f32 v243, v243
    s_nop 0
    v_cvt_pk_bf16_f32 v243, v243, v243
    v_lshlrev_b32 v243, 16, v243
    v_rcp_f32 v243, v243
    v_fma_f32 v244, v244, v245, v246
    v_mul_f32 v217, v244, v243
    v_mul_f32 v216, v245, v243
    s_waitcnt vmcnt(8)
    v_readfirstlane_b32 s63, v236
    s_mov_b32 s23, 0x20000
L_tk1:
    s_cmp_lg_u32 s63, 0
    s_cbranch_scc1 L_tk1x
    s_sub_u32 s23, s23, 1
    s_cmp_eq_u32 s23, 0
    s_cbranch_scc1 L_tk1x
    s_sleep 4
    v_mov_b32 v242, 0
    buffer_load_dword v236, v242, s[64:67], 0 offen sc1
    s_waitcnt vmcnt(0)
    v_readfirstlane_b32 s63, v236
    s_branch L_tk1
L_tk1x:
    v_mov_b32 v219, s63
    s_mov_b32 s22, 14745600
    s_mov_b32 exec_lo, 1
    s_mov_b32 exec_hi, 1
    buffer_store_dwordx4 v[216:219], v249, s[24:27], s22 offen sc1
    s_mov_b64 exec, -1
    s_waitcnt vmcnt(9)
    s_barrier
    ds_read_b128 v[192:195], v238 offset:16384
    ds_read_b128 v[196:199], v238 offset:20480
    ds_read_b128 v[200:203], v238 offset:24576
    ds_read_b128 v[204:207], v238 offset:28672
    s_add_u32 m0, s19, 114688
    s_add_u32 s22, s18, 0
    buffer_load_dwordx4 v10, s[12:15], s22 offen lds
    s_add_u32 m0, s19, 118784
    s_add_u32 s22, s18, 32768
    buffer_load_dwordx4 v10, s[12:15], s22 offen lds
    s_add_u32 m0, s19, 122880
    s_add_u32 s22, s18, 65536
    buffer_load_dwordx4 v10, s[12:15], s22 offen lds
    s_add_u32 m0, s19, 126976
    s_add_u32 s22, s18, 98304
    buffer_load_dwordx4 v10, s[12:15], s22 offen lds
    s_add_u32 m0, s19, 98304
    s_nop 0
    buffer_load_dwordx4 v13, s[8:11], s17 offen lds
    s_add_u32 m0, s19, 102400
    s_nop 0
    buffer_load_dwordx4 v14, s[8:11], s17 offen lds
    s_add_u32 m0, s19, 106496
    s_nop 0
    buffer_load_dwordx4 v15, s[8:11], s17 offen lds
    s_add_u32 m0, s19, 110592
    s_nop 0
    buffer_load_dwordx4 v16, s[8:11], s17 offen lds
    s_add_u32 s17, s17, 128
    s_add_u32 s18, s18, 128
    s_cmp_eq_u32 s17, 1024
    s_cselect_b32 s17, 0, s17
    s_cselect_b32 s22, 1024, 0
    s_sub_u32 s18, s18, s22
    s_waitcnt lgkmcnt(0)
    v_lshlrev_b32 v208, 16, v192
    v_and_b32 v212, 0xffff0000, v192
    v_lshlrev_b32 v209, 16, v196
    v_and_b32 v213, 0xffff0000, v196
    v_lshlrev_b32 v210, 16, v200
    v_and_b32 v214, 0xffff0000, v200
    v_lshlrev_b32 v211, 16, v204
    v_and_b32 v215, 0xffff0000, v204
    v_lshlrev_b32 v242, 16, v193
    v_and_b32 v193, 0xffff0000, v193
    v_lshlrev_b32 v243, 16, v197
    v_and_b32 v197, 0xffff0000, v197
    v_lshlrev_b32 v244, 16, v201
    v_and_b32 v201, 0xffff0000, v201
    v_lshlrev_b32 v245, 16, v205
    v_and_b32 v205, 0xffff0000, v205
    v_add_f32 v208, v208, v242
    v_add_f32 v212, v212, v193
    v_add_f32 v209, v209, v243
    v_add_f32 v213, v213, v197
    v_add_f32 v210, v210, v244
    v_add_f32 v214, v214, v201
    v_add_f32 v211, v211, v245
    v_add_f32 v215, v215, v205
    v_lshlrev_b32 v242, 16, v194
    v_and_b32 v194, 0xffff0000, v194
    v_lshlrev_b32 v243, 16, v198
    v_and_b32 v198, 0xffff0000, v198
    v_lshlrev_b32 v244, 16, v202
    v_and_b32 v202, 0xffff0000, v202
    v_lshlrev_b32 v245, 16, v206
    v_and_b32 v206, 0xffff0000, v206
    v_add_f32 v208, v208, v242
    v_add_f32 v212, v212, v194
    v_add_f32 v209, v209, v243
    v_add_f32 v213, v213, v198
    v_add_f32 v210, v210, v244
    v_add_f32 v214, v214, v202
    v_add_f32 v211, v211, v245
    v_add_f32 v215, v215, v206
    v_lshlrev_b32 v242, 16, v195
    v_and_b32 v195, 0xffff0000, v195
    v_lshlrev_b32 v243, 16, v199
    v_and_b32 v199, 0xffff0000, v199
    v_lshlrev_b32 v244, 16, v203
    v_and_b32 v203, 0xffff0000, v203
    v_lshlrev_b32 v245, 16, v207
    v_and_b32 v207, 0xffff0000, v207
    v_add_f32 v208, v208, v242
    v_add_f32 v212, v212, v195
    v_add_f32 v209, v209, v243
    v_add_f32 v213, v213, v199
    v_add_f32 v210, v210, v244
    v_add_f32 v214, v214, v203
    v_add_f32 v211, v211, v245
    v_add_f32 v215, v215, v207
    v_and_b32 v5, 3, v1
    v_lshlrev_b32 v4, 8, v5
    v_lshl_add_u32 v4, v2, 3, v4
    v_add_f32 v208, v208, v212
    v_add_f32 v209, v209, v213
    v_add_f32 v210, v210, v214
    v_add_f32 v211, v211, v215
    s_lshl_b32 s22, s16, 6
    s_add_u32 s22, s22, s20
    v_add_f32_dpp v208, v208, v208 quad_perm:[1,0,3,2] row_mask:0xf bank_mask:0xf
    v_add_f32_dpp v209, v209, v209 quad_perm:[1,0,3,2] row_mask:0xf bank_mask:0xf
    v_add_f32_dpp v210, v210, v210 quad_perm:[1,0,3,2] row_mask:0xf bank_mask:0xf
    v_add_f32_dpp v211, v211, v211 quad_perm:[1,0,3,2] row_mask:0xf bank_mask:0xf
    v_add_f32_dpp v208, v208, v208 quad_perm:[2,3,0,1] row_mask:0xf bank_mask:0xf
    v_add_f32_dpp v209, v209, v209 quad_perm:[2,3,0,1] row_mask:0xf bank_mask:0xf
    v_add_f32_dpp v210, v210, v210 quad_perm:[2,3,0,1] row_mask:0xf bank_mask:0xf
    v_add_f32_dpp v211, v211, v211 quad_perm:[2,3,0,1] row_mask:0xf bank_mask:0xf
    v_add_f32_dpp v208, v208, v208 row_half_mirror row_mask:0xf bank_mask:0xf
    v_add_f32_dpp v209, v209, v209 row_half_mirror row_mask:0xf bank_mask:0xf
    v_add_f32_dpp v210, v210, v210 row_half_mirror row_mask:0xf bank_mask:0xf
    v_add_f32_dpp v211, v211, v211 row_half_mirror row_mask:0xf bank_mask:0xf
    v_cmp_eq_u32 vcc, 1, v5
    s_nop 1
    v_cndmask_b32 v208, v208, v209, vcc
    v_cmp_eq_u32 vcc, 2, v5
    s_nop 1
    v_cndmask_b32 v208, v208, v210, vcc
    v_cmp_eq_u32 vcc, 3, v5
    s_nop 1
    v_cndmask_b32 v208, v208, v211, vcc
    v_mov_b32 v209, s63
    s_mov_b32 exec_lo, 0x0f0f0f0f
    s_mov_b32 exec_hi, 0x0f0f0f0f
    buffer_store_dwordx2 v[208:209], v4, s[24:27], s22 offen sc1
    s_mov_b64 exec, -1
    s_waitcnt vmcnt(8)
    s_barrier
    s_add_u32 m0, s19, 16384
    s_add_u32 s22, s18, 0
    buffer_load_dwordx4 v10, s[12:15], s22 offen lds
    s_add_u32 m0, s19, 20480
    s_add_u32 s22, s18, 32768
    buffer_load_dwordx4 v10, s[12:15], s22 offen lds
    s_add_u32 m0, s19, 24576
    s_add_u32 s22, s18, 65536
    buffer_load_dwordx4 v10, s[12:15], s22 offen lds
    s_add_u32 m0, s19, 28672
    s_add_u32 s22, s18, 98304
    buffer_load_dwordx4 v10, s[12:15], s22 offen lds
    s_add_u32 m0, s19, 0
    s_nop 0
    buffer_load_dwordx4 v13, s[8:11], s17 offen lds
    s_add_u32 m0, s19, 4096
    s_nop 0
    buffer_load_dwordx4 v14, s[8:11], s17 offen lds
    s_add_u32 m0, s19, 8192
    s_nop 0
    buffer_load_dwordx4 v15, s[8:11], s17 offen lds
    s_add_u32 m0, s19, 12288
    s_nop 0
    buffer_load_dwordx4 v16, s[8:11], s17 offen lds
    s_add_u32 s17, s17, 128
    s_add_u32 s18, s18, 128
    s_cmp_eq_u32 s17, 1024
    s_cselect_b32 s17, 0, s17
    s_cselect_b32 s22, 1024, 0
    s_sub_u32 s18, s18, s22
    s_waitcnt vmcnt(8)
    s_barrier
    s_add_u32 m0, s19, 49152
    s_add_u32 s22, s18, 0
    buffer_load_dwordx4 v10, s[12:15], s22 offen lds
    s_add_u32 m0, s19, 53248
    s_add_u32 s22, s18, 32768
    buffer_load_dwordx4 v10, s[12:15], s22 offen lds
    s_add_u32 m0, s19, 57344
    s_add_u32 s22, s18, 65536
    buffer_load_dwordx4 v10, s[12:15], s22 offen lds
    s_add_u32 m0, s19, 61440
    s_add_u32 s22, s18, 98304
    buffer_load_dwordx4 v10, s[12:15], s22 offen lds
    s_add_u32 m0, s19, 32768
    s_nop 0
    buffer_load_dwordx4 v13, s[8:11], s17 offen lds
    s_add_u32 m0, s19, 36864
    s_nop 0
    buffer_load_dwordx4 v14, s[8:11], s17 offen lds
    s_add_u32 m0, s19, 40960
    s_nop 0
    buffer_load_dwordx4 v15, s[8:11], s17 offen lds
    s_add_u32 m0, s19, 45056
    s_nop 0
    buffer_load_dwordx4 v16, s[8:11], s17 offen lds
    s_add_u32 s17, s17, 128
    s_add_u32 s18, s18, 128
    s_cmp_eq_u32 s17, 1024
    s_cselect_b32 s17, 0, s17
    s_cselect_b32 s22, 1024, 0
    s_sub_u32 s18, s18, s22
    s_waitcnt vmcnt(8)
    s_barrier
    s_add_u32 m0, s19, 81920
    s_add_u32 s22, s18, 0
    buffer_load_dwordx4 v10, s[12:15], s22 offen lds
    s_add_u32 m0, s19, 86016
    s_add_u32 s22, s18, 32768
    buffer_load_dwordx4 v10, s[12:15], s22 offen lds
    s_add_u32 m0, s19, 90112
    s_add_u32 s22, s18, 65536
    buffer_load_dwordx4 v10, s[12:15], s22 offen lds
    s_add_u32 m0, s19, 94208
    s_add_u32 s22, s18, 98304
    buffer_load_dwordx4 v10, s[12:15], s22 offen lds
    s_add_u32 m0, s19, 65536
    s_nop 0
    buffer_load_dwordx4 v13, s[8:11], s17 offen lds
    s_add_u32 m0, s19, 69632
    s_nop 0
    buffer_load_dwordx4 v14, s[8:11], s17 offen lds
    s_add_u32 m0, s19, 73728
    s_nop 0
    buffer_load_dwordx4 v15, s[8:11], s17 offen lds
    s_add_u32 m0, s19, 77824
    s_nop 0
    buffer_load_dwordx4 v16, s[8:11], s17 offen lds
    s_add_u32 s17, s17, 128
    s_add_u32 s18, s18, 128
    s_cmp_eq_u32 s17, 1024
    s_cselect_b32 s17, 0, s17
    s_cselect_b32 s22, 1024, 0
    s_sub_u32 s18, s18, s22
    s_waitcnt vmcnt(8)
    s_barrier
    s_add_u32 m0, s19, 114688
    s_add_u32 s22, s18, 0
    buffer_load_dwordx4 v10, s[12:15], s22 offen lds
    s_add_u32 m0, s19, 118784
    s_add_u32 s22, s18, 32768
    buffer_load_dwordx4 v10, s[12:15], s22 offen lds
    s_add_u32 m0, s19, 122880
    s_add_u32 s22, s18, 65536
    buffer_load_dwordx4 v10, s[12:15], s22 offen lds
    s_add_u32 m0, s19, 126976
    s_add_u32 s22, s18, 98304
    buffer_load_dwordx4 v10, s[12:15], s22 offen lds
    s_add_u32 m0, s19, 98304
    s_nop 0
    buffer_load_dwordx4 v13, s[8:11], s17 offen lds
    s_add_u32 m0, s19, 102400
    s_nop 0
    buffer_load_dwordx4 v14, s[8:11], s17 offen lds
    s_add_u32 m0, s19, 106496
    s_nop 0
    buffer_load_dwordx4 v15, s[8:11], s17 offen lds
    s_add_u32 m0, s19, 110592
    s_nop 0
    buffer_load_dwordx4 v16, s[8:11], s17 offen lds
    s_waitcnt vmcnt(8)
    s_barrier
    buffer_load_dwordx4 v[224:227], v237, s[24:27], 0 offen sc1
    buffer_load_dwordx4 v[228:231], v239, s[24:27], s21 offen sc1
    buffer_load_dwordx4 v[232:235], v239, s[24:27], s21 offen offset:16 sc1
    s_waitcnt vmcnt(3)
    s_barrier
    v_and_b32 v4, 1, v1
    v_bfe_u32 v5, v1, 1, 1
    v_lshlrev_b32 v4, 7, v4
    v_lshl_add_u32 v4, v5, 9, v4
    v_lshl_add_u32 v4, v2, 2, v4
    s_lshl_b32 s22, s16, 5
    s_add_u32 s22, s22, 131072
    v_add_u32 v4, s22, v4
    v_mov_b32 v5, 162572
    v_and_b32 v6, 7, v1
    v_lshlrev_b32 v6, 4, v6
    v_and_b32 v7, 1, v3
    v_lshl_add_u32 v6, v7, 3, v6
    v_lshrrev_b32 v7, 5, v1
    v_lshl_add_u32 v6, v7, 2, v6
    s_lshl_b32 s22, s16, 7
    s_add_u32 s22, s22, 132096
    v_add_u32 v6, s22, v6
    s_mov_b32 s23, 0x10000
    s_waitcnt vmcnt(0)
L_ga2:
    v_xor_b32 v7, s63, v227
    v_xor_b32 v8, s63, v229
    v_or_b32 v7, v7, v8
    v_xor_b32 v8, s63, v231
    v_or_b32 v7, v7, v8
    v_xor_b32 v8, s63, v233
    v_or_b32 v7, v7, v8
    v_xor_b32 v8, s63, v235
    v_or_b32 v7, v7, v8
    v_cmp_ne_u32 vcc, 0, v7
    s_cbranch_vccz L_ga2x
    s_sub_u32 s23, s23, 1
    s_cmp_eq_u32 s23, 0
    s_cbranch_scc1 L_ga2x
    s_sleep 4
    buffer_load_dwordx4 v[224:227], v237, s[24:27], 0 offen sc1
    buffer_load_dwordx4 v[228:231], v239, s[24:27], s21 offen sc1
    buffer_load_dwordx4 v[232:235], v239, s[24:27], s21 offen offset:16 sc1
    s_waitcnt vmcnt(0)
    s_branch L_ga2
L_ga2x:
    v_permlane32_swap_b32 v228, v230
    v_permlane32_swap_b32 v232, v234
    v_and_b32 v224, 0xffff0000, v226
    v_rcp_f32 v224, v224
    v_add_f32 v228, v228, v230
    v_add_f32 v232, v232, v234
    v_lshlrev_b32 v225, 16, v226
    v_mul_f32 v225, v225, v224
    v_permlane16_swap_b32 v228, v232
    ds_write_b32 v4, v224
    v_add_f32 v228, v228, v232
    ds_write_b32 v4, v225 offset:256
    ds_write_b32 v5, v227
    v_add_f32_dpp v228, v228, v228 row_ror:8 row_mask:0xf bank_mask:0xf
    ds_write_b32 v6, v228
    s_waitcnt lgkmcnt(0)
    s_barrier
    s_branch L_p2_z
L_k1a_cons:
    v_and_b32 v1, 63, v0
    s_lshr_b32 s22, s2, 3
    s_cmp_lg_u32 s16, 0
    s_cbranch_scc1 L_pf3
    s_lshr_b32 s23, s22, 2
    s_lshl_b32 s23, s23, 18
    s_and_b32 s22, s22, 3
    s_lshl_b32 s22, s22, 13
    s_add_u32 s22, s22, s23
    s_and_b32 s23, s2, 7
    s_lshl_b32 s23, s23, 15
    s_add_u32 s22, s22, s23
    s_mov_b32 s88, s6
    s_mov_b32 s89, s7
    s_mov_b32 s90, 1409024
    s_mov_b32 s91, 0x20000
    v_lshlrev_b32 v13, 7, v1
    buffer_load_dword v13, v13, s[88:91], s22 offen
L_pf3:
    s_and_b32 s22, s2, 6
    s_sub_u32 s23, 12, s22
    s_cmp_lt_u32 s2, 128
    s_cselect_b32 s22, s22, s23
    s_lshr_b32 s23, s2, 6
    s_add_u32 s22, s22, s23
    s_lshl_b32 s22, s22, 6
    s_and_b32 s23, s2, 1
    s_add_u32 s22, s22, s23
    v_and_b32 v8, 15, v1
    v_lshl_add_u32 v8, v8, 1, s22
    v_lshlrev_b32 v42, 12, v8
    v_add_u32 v43, 131072, v42
    v_lshrrev_b32 v8, 4, v1
    s_lshr_b32 s22, s16, 1
    s_lshl_b32 s22, s22, 8
    v_lshl_add_u32 v8, v8, 3, s22
    v_mul_lo_u32 v40, v8, v42
    v_mul_lo_u32 v41, v8, v43
    s_and_b32 s22, s16, 1
    s_lshl_b32 s22, s22, 21
    v_add_u32 v40, s22, v40
    v_add_u32 v41, s22, v41
    v_mov_b32 v44, 1.0
    v_mul_u32_u24 v45, 24, v42
    v_mul_u32_u24 v46, 24, v43
    s_mov_b32 s59, 0x7ff000
    v_and_or_b32 v32, v40, s59, v44
    v_add_u32 v40, v40, v42
    v_and_or_b32 v33, v40, s59, v44
    v_add_u32 v40, v40, v42
    v_and_or_b32 v34, v40, s59, v44
    v_add_u32 v40, v40, v42
    v_and_or_b32 v35, v40, s59, v44
    v_add_u32 v40, v40, v42
    v_and_or_b32 v36, v40, s59, v44
    v_add_u32 v40, v40, v42
    v_and_or_b32 v37, v40, s59, v44
    v_add_u32 v40, v40, v42
    v_and_or_b32 v38, v40, s59, v44
    v_add_u32 v40, v40, v42
    v_and_or_b32 v39, v40, s59, v44
    v_add_u32 v40, v40, v42
    v_cos_f32 v32, v32
    v_cos_f32 v33, v33
    v_cos_f32 v34, v34
    v_cos_f32 v35, v35
    v_cos_f32 v36, v36
    v_cos_f32 v37, v37
    v_cos_f32 v38, v38
    v_cos_f32 v39, v39
    v_add_u32 v40, v40, v45
    v_cvt_pk_bf16_f32 v192, v32, v33
    v_cvt_pk_bf16_f32 v193, v34, v35
    v_cvt_pk_bf16_f32 v194, v36, v37
    v_cvt_pk_bf16_f32 v195, v38, v39
    v_and_or_b32 v32, v41, s59, v44
    v_add_u32 v41, v41, v43
    v_and_or_b32 v33, v41, s59, v44
    v_add_u32 v41, v41, v43
    v_and_or_b32 v34, v41, s59, v44
    v_add_u32 v41, v41, v43
    v_and_or_b32 v35, v41, s59, v44
    v_add_u32 v41, v41, v43
    v_and_or_b32 v36, v41, s59, v44
    v_add_u32 v41, v41, v43
    v_and_or_b32 v37, v41, s59, v44
    v_add_u32 v41, v41, v43
    v_and_or_b32 v38, v41, s59, v44
    v_add_u32 v41, v41, v43
    v_and_or_b32 v39, v41, s59, v44
    v_add_u32 v41, v41, v43
    v_cos_f32 v32, v32
    v_cos_f32 v33, v33
    v_cos_f32 v34, v34
    v_cos_f32 v35, v35
    v_cos_f32 v36, v36
    v_cos_f32 v37, v37
    v_cos_f32 v38, v38
    v_cos_f32 v39, v39
    v_add_u32 v41, v41, v46
    v_cvt_pk_bf16_f32 v196, v32, v33
    v_cvt_pk_bf16_f32 v197, v34, v35
    v_cvt_pk_bf16_f32 v198, v36, v37
    v_cvt_pk_bf16_f32 v199, v38, v39
    v_and_or_b32 v32, v40, s59, v44
    v_add_u32 v40, v40, v42
    v_and_or_b32 v33, v40, s59, v44
    v_add_u32 v40, v40, v42
    v_and_or_b32 v34, v40, s59, v44
    v_add_u32 v40, v40, v42
    v_and_or_b32 v35, v40, s59, v44
    v_add_u32 v40, v40, v42
    v_and_or_b32 v36, v40, s59, v44
    v_add_u32 v40, v40, v42
    v_and_or_b32 v37, v40, s59, v44
    v_add_u32 v40, v40, v42
    v_and_or_b32 v38, v40, s59, v44
    v_add_u32 v40, v40, v42
    v_and_or_b32 v39, v40, s59, v44
    v_add_u32 v40, v40, v42
    v_cos_f32 v32, v32
    v_cos_f32 v33, v33
    v_cos_f32 v34, v34
    v_cos_f32 v35, v35
    v_cos_f32 v36, v36
    v_cos_f32 v37, v37
    v_cos_f32 v38, v38
    v_cos_f32 v39, v39
    v_add_u32 v40, v40, v45
    v_cvt_pk_bf16_f32 v200, v32, v33
    v_cvt_pk_bf16_f32 v201, v34, v35
    v_cvt_pk_bf16_f32 v202, v36, v37
    v_cvt_pk_bf16_f32 v203, v38, v39
    v_and_or_b32 v32, v41, s59, v44
    v_add_u32 v41, v41, v43
    v_and_or_b32 v33, v41, s59, v44
    v_add_u32 v41, v41, v43
    v_and_or_b32 v34, v41, s59, v44
    v_add_u32 v41, v41, v43
    v_and_or_b32 v35, v41, s59, v44
    v_add_u32 v41, v41, v43
    v_and_or_b32 v36, v41, s59, v44
    v_add_u32 v41, v41, v43
    v_and_or_b32 v37, v41, s59, v44
    v_add_u32 v41, v41, v43
    v_and_or_b32 v38, v41, s59, v44
    v_add_u32 v41, v41, v43
    v_and_or_b32 v39, v41, s59, v44
    v_add_u32 v41, v41, v43
    v_cos_f32 v32, v32
    v_cos_f32 v33, v33
    v_cos_f32 v34, v34
    v_cos_f32 v35, v35
    v_cos_f32 v36, v36
    v_cos_f32 v37, v37
    v_cos_f32 v38, v38
    v_cos_f32 v39, v39
    v_add_u32 v41, v41, v46
    v_cvt_pk_bf16_f32 v204, v32, v33
    v_cvt_pk_bf16_f32 v205, v34, v35
    v_cvt_pk_bf16_f32 v206, v36, v37
    v_cvt_pk_bf16_f32 v207, v38, v39
    v_and_or_b32 v32, v40, s59, v44
    v_add_u32 v40, v40, v42
    v_and_or_b32 v33, v40, s59, v44
    v_add_u32 v40, v40, v42
    v_and_or_b32 v34, v40, s59, v44
    v_add_u32 v40, v40, v42
    v_and_or_b32 v35, v40, s59, v44
    v_add_u32 v40, v40, v42
    v_and_or_b32 v36, v40, s59, v44
    v_add_u32 v40, v40, v42
    v_and_or_b32 v37, v40, s59, v44
    v_add_u32 v40, v40, v42
    v_and_or_b32 v38, v40, s59, v44
    v_add_u32 v40, v40, v42
    v_and_or_b32 v39, v40, s59, v44
    v_add_u32 v40, v40, v42
    v_cos_f32 v32, v32
    v_cos_f32 v33, v33
    v_cos_f32 v34, v34
    v_cos_f32 v35, v35
    v_cos_f32 v36, v36
    v_cos_f32 v37, v37
    v_cos_f32 v38, v38
    v_cos_f32 v39, v39
    v_add_u32 v40, v40, v45
    v_cvt_pk_bf16_f32 v208, v32, v33
    v_cvt_pk_bf16_f32 v209, v34, v35
    v_cvt_pk_bf16_f32 v210, v36, v37
    v_cvt_pk_bf16_f32 v211, v38, v39
    v_and_or_b32 v32, v41, s59, v44
    v_add_u32 v41, v41, v43
    v_and_or_b32 v33, v41, s59, v44
    v_add_u32 v41, v41, v43
    v_and_or_b32 v34, v41, s59, v44
    v_add_u32 v41, v41, v43
    v_and_or_b32 v35, v41, s59, v44
    v_add_u32 v41, v41, v43
    v_and_or_b32 v36, v41, s59, v44
    v_add_u32 v41, v41, v43
    v_and_or_b32 v37, v41, s59, v44
    v_add_u32 v41, v41, v43
    v_and_or_b32 v38, v41, s59, v44
    v_add_u32 v41, v41, v43
    v_and_or_b32 v39, v41, s59, v44
    v_add_u32 v41, v41, v43
    v_cos_f32 v32, v32
    v_cos_f32 v33, v33
    v_cos_f32 v34, v34
    v_cos_f32 v35, v35
    v_cos_f32 v36, v36
    v_cos_f32 v37, v37
    v_cos_f32 v38, v38
    v_cos_f32 v39, v39
    v_add_u32 v41, v41, v46
    v_cvt_pk_bf16_f32 v212, v32, v33
    v_cvt_pk_bf16_f32 v213, v34, v35
    v_cvt_pk_bf16_f32 v214, v36, v37
    v_cvt_pk_bf16_f32 v215, v38, v39
    v_and_or_b32 v32, v40, s59, v44
    v_add_u32 v40, v40, v42
    v_and_or_b32 v33, v40, s59, v44
    v_add_u32 v40, v40, v42
    v_and_or_b32 v34, v40, s59, v44
    v_add_u32 v40, v40, v42
    v_and_or_b32 v35, v40, s59, v44
    v_add_u32 v40, v40, v42
    v_and_or_b32 v36, v40, s59, v44
    v_add_u32 v40, v40, v42
    v_and_or_b32 v37, v40, s59, v44
    v_add_u32 v40, v40, v42
    v_and_or_b32 v38, v40, s59, v44
    v_add_u32 v40, v40, v42
    v_and_or_b32 v39, v40, s59, v44
    v_add_u32 v40, v40, v42
    v_cos_f32 v32, v32
    v_cos_f32 v33, v33
    v_cos_f32 v34, v34
    v_cos_f32 v35, v35
    v_cos_f32 v36, v36
    v_cos_f32 v37, v37
    v_cos_f32 v38, v38
    v_cos_f32 v39, v39
    v_add_u32 v40, v40, v45
    v_cvt_pk_bf16_f32 v216, v32, v33
    v_cvt_pk_bf16_f32 v217, v34, v35
    v_cvt_pk_bf16_f32 v218, v36, v37
    v_cvt_pk_bf16_f32 v219, v38, v39
    v_and_or_b32 v32, v41, s59, v44
    v_add_u32 v41, v41, v43
    v_and_or_b32 v33, v41, s59, v44
    v_add_u32 v41, v41, v43
    v_and_or_b32 v34, v41, s59, v44
    v_add_u32 v41, v41, v43
    v_and_or_b32 v35, v41, s59, v44
    v_add_u32 v41, v41, v43
    v_and_or_b32 v36, v41, s59, v44
    v_add_u32 v41, v41, v43
    v_and_or_b32 v37, v41, s59, v44
    v_add_u32 v41, v41, v43
    v_and_or_b32 v38, v41, s59, v44
    v_add_u32 v41, v41, v43
    v_and_or_b32 v39, v41, s59, v44
    v_add_u32 v41, v41, v43
    v_cos_f32 v32, v32
    v_cos_f32 v33, v33
    v_cos_f32 v34, v34
    v_cos_f32 v35, v35
    v_cos_f32 v36, v36
    v_cos_f32 v37, v37
    v_cos_f32 v38, v38
    v_cos_f32 v39, v39
    v_add_u32 v41, v41, v46
    v_cvt_pk_bf16_f32 v220, v32, v33
    v_cvt_pk_bf16_f32 v221, v34, v35
    v_cvt_pk_bf16_f32 v222, v36, v37
    v_cvt_pk_bf16_f32 v223, v38, v39
    v_and_or_b32 v32, v40, s59, v44
    v_add_u32 v40, v40, v42
    v_and_or_b32 v33, v40, s59, v44
    v_add_u32 v40, v40, v42
    v_and_or_b32 v34, v40, s59, v44
    v_add_u32 v40, v40, v42
    v_and_or_b32 v35, v40, s59, v44
    v_add_u32 v40, v40, v42
    v_and_or_b32 v36, v40, s59, v44
    v_add_u32 v40, v40, v42
    v_and_or_b32 v37, v40, s59, v44
    v_add_u32 v40, v40, v42
    v_and_or_b32 v38, v40, s59, v44
    v_add_u32 v40, v40, v42
    v_and_or_b32 v39, v40, s59, v44
    v_add_u32 v40, v40, v42
    v_cos_f32 v32, v32
    v_cos_f32 v33, v33
    v_cos_f32 v34, v34
    v_cos_f32 v35, v35
    v_cos_f32 v36, v36
    v_cos_f32 v37, v37
    v_cos_f32 v38, v38
    v_cos_f32 v39, v39
    v_add_u32 v40, v40, v45
    v_cvt_pk_bf16_f32 v224, v32, v33
    v_cvt_pk_bf16_f32 v225, v34, v35
    v_cvt_pk_bf16_f32 v226, v36, v37
    v_cvt_pk_bf16_f32 v227, v38, v39
    v_and_or_b32 v32, v41, s59, v44
    v_add_u32 v41, v41, v43
    v_and_or_b32 v33, v41, s59, v44
    v_add_u32 v41, v41, v43
    v_and_or_b32 v34, v41, s59, v44
    v_add_u32 v41, v41, v43
    v_and_or_b32 v35, v41, s59, v44
    v_add_u32 v41, v41, v43
    v_and_or_b32 v36, v41, s59, v44
    v_add_u32 v41, v41, v43
    v_and_or_b32 v37, v41, s59, v44
    v_add_u32 v41, v41, v43
    v_and_or_b32 v38, v41, s59, v44
    v_add_u32 v41, v41, v43
    v_and_or_b32 v39, v41, s59, v44
    v_add_u32 v41, v41, v43
    v_cos_f32 v32, v32
    v_cos_f32 v33, v33
    v_cos_f32 v34, v34
    v_cos_f32 v35, v35
    v_cos_f32 v36, v36
    v_cos_f32 v37, v37
    v_cos_f32 v38, v38
    v_cos_f32 v39, v39
    v_add_u32 v41, v41, v46
    v_cvt_pk_bf16_f32 v228, v32, v33
    v_cvt_pk_bf16_f32 v229, v34, v35
    v_cvt_pk_bf16_f32 v230, v36, v37
    v_cvt_pk_bf16_f32 v231, v38, v39
    v_and_or_b32 v32, v40, s59, v44
    v_add_u32 v40, v40, v42
    v_and_or_b32 v33, v40, s59, v44
    v_add_u32 v40, v40, v42
    v_and_or_b32 v34, v40, s59, v44
    v_add_u32 v40, v40, v42
    v_and_or_b32 v35, v40, s59, v44
    v_add_u32 v40, v40, v42
    v_and_or_b32 v36, v40, s59, v44
    v_add_u32 v40, v40, v42
    v_and_or_b32 v37, v40, s59, v44
    v_add_u32 v40, v40, v42
    v_and_or_b32 v38, v40, s59, v44
    v_add_u32 v40, v40, v42
    v_and_or_b32 v39, v40, s59, v44
    v_add_u32 v40, v40, v42
    v_cos_f32 v32, v32
    v_cos_f32 v33, v33
    v_cos_f32 v34, v34
    v_cos_f32 v35, v35
    v_cos_f32 v36, v36
    v_cos_f32 v37, v37
    v_cos_f32 v38, v38
    v_cos_f32 v39, v39
    v_add_u32 v40, v40, v45
    v_cvt_pk_bf16_f32 v232, v32, v33
    v_cvt_pk_bf16_f32 v233, v34, v35
    v_cvt_pk_bf16_f32 v234, v36, v37
    v_cvt_pk_bf16_f32 v235, v38, v39
    v_and_or_b32 v32, v41, s59, v44
    v_add_u32 v41, v41, v43
    v_and_or_b32 v33, v41, s59, v44
    v_add_u32 v41, v41, v43
    v_and_or_b32 v34, v41, s59, v44
    v_add_u32 v41, v41, v43
    v_and_or_b32 v35, v41, s59, v44
    v_add_u32 v41, v41, v43
    v_and_or_b32 v36, v41, s59, v44
    v_add_u32 v41, v41, v43
    v_and_or_b32 v37, v41, s59, v44
    v_add_u32 v41, v41, v43
    v_and_or_b32 v38, v41, s59, v44
    v_add_u32 v41, v41, v43
    v_and_or_b32 v39, v41, s59, v44
    v_add_u32 v41, v41, v43
    v_cos_f32 v32, v32
    v_cos_f32 v33, v33
    v_cos_f32 v34, v34
    v_cos_f32 v35, v35
    v_cos_f32 v36, v36
    v_cos_f32 v37, v37
    v_cos_f32 v38, v38
    v_cos_f32 v39, v39
    v_add_u32 v41, v41, v46
    v_cvt_pk_bf16_f32 v236, v32, v33
    v_cvt_pk_bf16_f32 v237, v34, v35
    v_cvt_pk_bf16_f32 v238, v36, v37
    v_cvt_pk_bf16_f32 v239, v38, v39
    v_and_or_b32 v32, v40, s59, v44
    v_add_u32 v40, v40, v42
    v_and_or_b32 v33, v40, s59, v44
    v_add_u32 v40, v40, v42
    v_and_or_b32 v34, v40, s59, v44
    v_add_u32 v40, v40, v42
    v_and_or_b32 v35, v40, s59, v44
    v_add_u32 v40, v40, v42
    v_and_or_b32 v36, v40, s59, v44
    v_add_u32 v40, v40, v42
    v_and_or_b32 v37, v40, s59, v44
    v_add_u32 v40, v40, v42
    v_and_or_b32 v38, v40, s59, v44
    v_add_u32 v40, v40, v42
    v_and_or_b32 v39, v40, s59, v44
    v_add_u32 v40, v40, v42
    v_cos_f32 v32, v32
    v_cos_f32 v33, v33
    v_cos_f32 v34, v34
    v_cos_f32 v35, v35
    v_cos_f32 v36, v36
    v_cos_f32 v37, v37
    v_cos_f32 v38, v38
    v_cos_f32 v39, v39
    v_add_u32 v40, v40, v45
    v_cvt_pk_bf16_f32 v240, v32, v33
    v_cvt_pk_bf16_f32 v241, v34, v35
    v_cvt_pk_bf16_f32 v242, v36, v37
    v_cvt_pk_bf16_f32 v243, v38, v39
    v_and_or_b32 v32, v41, s59, v44
    v_add_u32 v41, v41, v43
    v_and_or_b32 v33, v41, s59, v44
    v_add_u32 v41, v41, v43
    v_and_or_b32 v34, v41, s59, v44
    v_add_u32 v41, v41, v43
    v_and_or_b32 v35, v41, s59, v44
    v_add_u32 v41, v41, v43
    v_and_or_b32 v36, v41, s59, v44
    v_add_u32 v41, v41, v43
    v_and_or_b32 v37, v41, s59, v44
    v_add_u32 v41, v41, v43
    v_and_or_b32 v38, v41, s59, v44
    v_add_u32 v41, v41, v43
    v_and_or_b32 v39, v41, s59, v44
    v_add_u32 v41, v41, v43
    v_cos_f32 v32, v32
    v_cos_f32 v33, v33
    v_cos_f32 v34, v34
    v_cos_f32 v35, v35
    v_cos_f32 v36, v36
    v_cos_f32 v37, v37
    v_cos_f32 v38, v38
    v_cos_f32 v39, v39
    v_add_u32 v41, v41, v46
    v_cvt_pk_bf16_f32 v244, v32, v33
    v_cvt_pk_bf16_f32 v245, v34, v35
    v_cvt_pk_bf16_f32 v246, v36, v37
    v_cvt_pk_bf16_f32 v247, v38, v39
    v_and_or_b32 v32, v40, s59, v44
    v_add_u32 v40, v40, v42
    v_and_or_b32 v33, v40, s59, v44
    v_add_u32 v40, v40, v42
    v_and_or_b32 v34, v40, s59, v44
    v_add_u32 v40, v40, v42
    v_and_or_b32 v35, v40, s59, v44
    v_add_u32 v40, v40, v42
    v_and_or_b32 v36, v40, s59, v44
    v_add_u32 v40, v40, v42
    v_and_or_b32 v37, v40, s59, v44
    v_add_u32 v40, v40, v42
    v_and_or_b32 v38, v40, s59, v44
    v_add_u32 v40, v40, v42
    v_and_or_b32 v39, v40, s59, v44
    v_add_u32 v40, v40, v42
    v_cos_f32 v32, v32
    v_cos_f32 v33, v33
    v_cos_f32 v34, v34
    v_cos_f32 v35, v35
    v_cos_f32 v36, v36
    v_cos_f32 v37, v37
    v_cos_f32 v38, v38
    v_cos_f32 v39, v39
    s_nop 0
    v_cvt_pk_bf16_f32 v248, v32, v33
    v_cvt_pk_bf16_f32 v249, v34, v35
    v_cvt_pk_bf16_f32 v250, v36, v37
    v_cvt_pk_bf16_f32 v251, v38, v39
    v_and_or_b32 v32, v41, s59, v44
    v_add_u32 v41, v41, v43
    v_and_or_b32 v33, v41, s59, v44
    v_add_u32 v41, v41, v43
    v_and_or_b32 v34, v41, s59, v44
    v_add_u32 v41, v41, v43
    v_and_or_b32 v35, v41, s59, v44
    v_add_u32 v41, v41, v43
    v_and_or_b32 v36, v41, s59, v44
    v_add_u32 v41, v41, v43
    v_and_or_b32 v37, v41, s59, v44
    v_add_u32 v41, v41, v43
    v_and_or_b32 v38, v41, s59, v44
    v_add_u32 v41, v41, v43
    v_and_or_b32 v39, v41, s59, v44
    v_add_u32 v41, v41, v43
    v_cos_f32 v32, v32
    v_cos_f32 v33, v33
    v_cos_f32 v34, v34
    v_cos_f32 v35, v35
    v_cos_f32 v36, v36
    v_cos_f32 v37, v37
    v_cos_f32 v38, v38
    v_cos_f32 v39, v39
    s_nop 0
    v_cvt_pk_bf16_f32 v252, v32, v33
    v_cvt_pk_bf16_f32 v253, v34, v35
    v_cvt_pk_bf16_f32 v254, v36, v37
    v_cvt_pk_bf16_f32 v255, v38, v39
    v_and_b32 v2, 15, v1
    v_lshrrev_b32 v3, 1, v2
    v_lshrrev_b32 v4, 4, v1
    v_xor_b32 v3, v3, v4
    v_lshlrev_b32 v3, 4, v3
    v_lshlrev_b32 v2, 7, v2
    v_add_u32 v2, v2, v3
    s_lshr_b32 s34, s16, 1
    s_and_b32 s35, s16, 1
    s_lshl_b32 s22, s34, 13
    v_add_u32 v16, s22, v2
    v_xor_b32 v17, 64, v16
    s_lshl_b32 s23, s35, 13
    s_add_u32 s23, s23, 16384
    v_add_u32 v20, s23, v2
    v_xor_b32 v21, 64, v20
    v_add_u32 v18, 65536, v16
    v_add_u32 v19, 65536, v17
    v_add_u32 v24, 65536, v20
    v_add_u32 v25, 65536, v21
    v_mov_b32 v92, 0
    v_mov_b32 v93, 0
    v_mov_b32 v94, 0
    v_mov_b32 v95, 0
    v_mov_b32 v96, 0
    v_mov_b32 v97, 0
    v_mov_b32 v98, 0
    v_mov_b32 v99, 0
    v_mov_b32 v100, 0
    v_mov_b32 v101, 0
    v_mov_b32 v102, 0
    v_mov_b32 v103, 0
    v_mov_b32 v104, 0
    v_mov_b32 v105, 0
    v_mov_b32 v106, 0
    v_mov_b32 v107, 0
    v_mov_b32 v108, 0
    v_mov_b32 v109, 0
    v_mov_b32 v110, 0
    v_mov_b32 v111, 0
    v_mov_b32 v112, 0
    v_mov_b32 v113, 0
    v_mov_b32 v114, 0
    v_mov_b32 v115, 0
    v_mov_b32 v116, 0
    v_mov_b32 v117, 0
    v_mov_b32 v118, 0
    v_mov_b32 v119, 0
    v_mov_b32 v120, 0
    v_mov_b32 v121, 0
    v_mov_b32 v122, 0
    v_mov_b32 v123, 0
    v_mov_b32 v124, 0
    v_mov_b32 v125, 0
    v_mov_b32 v126, 0
    v_mov_b32 v127, 0
    v_mov_b32 v128, 0
    v_mov_b32 v129, 0
    v_mov_b32 v130, 0
    v_mov_b32 v131, 0
    v_mov_b32 v132, 0
    v_mov_b32 v133, 0
    v_mov_b32 v134, 0
    v_mov_b32 v135, 0
    v_mov_b32 v136, 0
    v_mov_b32 v137, 0
    v_mov_b32 v138, 0
    v_mov_b32 v139, 0
    v_mov_b32 v140, 0
    v_mov_b32 v141, 0
    v_mov_b32 v142, 0
    v_mov_b32 v143, 0
    v_mov_b32 v144, 0
    v_mov_b32 v145, 0
    v_mov_b32 v146, 0
    v_mov_b32 v147, 0
    v_mov_b32 v148, 0
    v_mov_b32 v149, 0
    v_mov_b32 v150, 0
    v_mov_b32 v151, 0
    v_mov_b32 v152, 0
    v_mov_b32 v153, 0
    v_mov_b32 v154, 0
    v_mov_b32 v155, 0
    v_and_b32 v2, 15, v1
    v_lshrrev_b32 v3, 4, v1
    v_lshlrev_b32 v4, 2, v2
    s_lshl_b32 s22, s35, 8
    s_add_u32 s22, s22, 132096
    s_lshl_b32 s23, s34, 9
    s_add_u32 s23, s23, 131072
    v_add_u32 v5, s22, v4
    v_lshl_add_u32 v6, v3, 4, s23
    v_mov_b32 v7, 162572
    s_mov_b32 s21, 0
    s_waitcnt lgkmcnt(0)
    s_barrier
    ds_read_b128 v[44:47], v20 offset:0
    ds_read_b128 v[48:51], v20 offset:2048
    ds_read_b128 v[52:55], v20 offset:4096
    ds_read_b128 v[56:59], v20 offset:6144
    ds_read_b128 v[28:31], v16 offset:0
    ds_read_b128 v[32:35], v16 offset:2048
    ds_read_b128 v[36:39], v16 offset:4096
    ds_read_b128 v[40:43], v16 offset:6144
L_k1a_loop:
    s_waitcnt lgkmcnt(3)
    v_cndmask_b32 v44, v44, v15, s[68:69]
    v_cndmask_b32 v45, v45, v15, s[68:69]
    v_cndmask_b32 v46, v46, v15, s[68:69]
    v_cndmask_b32 v47, v47, v15, s[68:69]
    v_mfma_f32_16x16x32_bf16 v[96:99], v[28:31], v[48:51], v[96:99]
    ds_read_b128 v[76:79], v21 offset:0
    v_mfma_f32_16x16x32_bf16 v[100:103], v[28:31], v[52:55], v[100:103]
    v_mfma_f32_16x16x32_bf16 v[104:107], v[28:31], v[56:59], v[104:107]
    ds_read_b128 v[80:83], v21 offset:2048
    v_mfma_f32_16x16x32_bf16 v[92:95], v[28:31], v[44:47], v[92:95]
    s_waitcnt lgkmcnt(4)
    v_mfma_f32_16x16x32_bf16 v[112:115], v[32:35], v[48:51], v[112:115]
    ds_read_b128 v[84:87], v21 offset:4096
    v_mfma_f32_16x16x32_bf16 v[116:119], v[32:35], v[52:55], v[116:119]
    v_mfma_f32_16x16x32_bf16 v[120:123], v[32:35], v[56:59], v[120:123]
    ds_read_b128 v[88:91], v21 offset:6144
    v_mfma_f32_16x16x32_bf16 v[108:111], v[32:35], v[44:47], v[108:111]
    s_waitcnt lgkmcnt(5)
    v_mfma_f32_16x16x32_bf16 v[128:131], v[36:39], v[48:51], v[128:131]
    ds_read_b128 v[60:63], v17 offset:0
    v_mfma_f32_16x16x32_bf16 v[132:135], v[36:39], v[52:55], v[132:135]
    v_mfma_f32_16x16x32_bf16 v[136:139], v[36:39], v[56:59], v[136:139]
    ds_read_b128 v[64:67], v17 offset:2048
    v_mfma_f32_16x16x32_bf16 v[124:127], v[36:39], v[44:47], v[124:127]
    s_waitcnt lgkmcnt(6)
    v_mfma_f32_16x16x32_bf16 v[144:147], v[40:43], v[48:51], v[144:147]
    ds_read_b128 v[68:71], v17 offset:4096
    v_mfma_f32_16x16x32_bf16 v[148:151], v[40:43], v[52:55], v[148:151]
    v_mfma_f32_16x16x32_bf16 v[152:155], v[40:43], v[56:59], v[152:155]
    ds_read_b128 v[72:75], v17 offset:6144
    v_mfma_f32_16x16x32_bf16 v[140:143], v[40:43], v[44:47], v[140:143]
    s_barrier
    s_waitcnt lgkmcnt(3)
    v_cndmask_b32 v76, v76, v15, s[68:69]
    v_cndmask_b32 v77, v77, v15, s[68:69]
    v_cndmask_b32 v78, v78, v15, s[68:69]
    v_cndmask_b32 v79, v79, v15, s[68:69]
    v_mfma_f32_16x16x32_bf16 v[96:99], v[60:63], v[80:83], v[96:99]
    ds_read_b128 v[44:47], v20 offset:32768
    v_mfma_f32_16x16x32_bf16 v[100:103], v[60:63], v[84:87], v[100:103]
    v_mfma_f32_16x16x32_bf16 v[104:107], v[60:63], v[88:91], v[104:107]
    ds_read_b128 v[48:51], v20 offset:34816
    v_mfma_f32_16x16x32_bf16 v[92:95], v[60:63], v[76:79], v[92:95]
    s_waitcnt lgkmcnt(4)
    v_mfma_f32_16x16x32_bf16 v[112:115], v[64:67], v[80:83], v[112:115]
    ds_read_b128 v[52:55], v20 offset:36864
    v_mfma_f32_16x16x32_bf16 v[116:119], v[64:67], v[84:87], v[116:119]
    v_mfma_f32_16x16x32_bf16 v[120:123], v[64:67], v[88:91], v[120:123]
    ds_read_b128 v[56:59], v20 offset:38912
    v_mfma_f32_16x16x32_bf16 v[108:111], v[64:67], v[76:79], v[108:111]
    s_waitcnt lgkmcnt(5)
    v_mfma_f32_16x16x32_bf16 v[128:131], v[68:71], v[80:83], v[128:131]
    ds_read_b128 v[28:31], v16 offset:32768
    v_mfma_f32_16x16x32_bf16 v[132:135], v[68:71], v[84:87], v[132:135]
    v_mfma_f32_16x16x32_bf16 v[136:139], v[68:71], v[88:91], v[136:139]
    ds_read_b128 v[32:35], v16 offset:34816
    v_mfma_f32_16x16x32_bf16 v[124:127], v[68:71], v[76:79], v[124:127]
    s_waitcnt lgkmcnt(6)
    v_mfma_f32_16x16x32_bf16 v[144:147], v[72:75], v[80:83], v[144:147]
    ds_read_b128 v[36:39], v16 offset:36864
    v_mfma_f32_16x16x32_bf16 v[148:151], v[72:75], v[84:87], v[148:151]
    v_mfma_f32_16x16x32_bf16 v[152:155], v[72:75], v[88:91], v[152:155]
    ds_read_b128 v[40:43], v16 offset:38912
    v_mfma_f32_16x16x32_bf16 v[140:143], v[72:75], v[76:79], v[140:143]
    s_waitcnt lgkmcnt(3)
    v_cndmask_b32 v44, v44, v15, s[68:69]
    v_cndmask_b32 v45, v45, v15, s[68:69]
    v_cndmask_b32 v46, v46, v15, s[68:69]
    v_cndmask_b32 v47, v47, v15, s[68:69]
    v_mfma_f32_16x16x32_bf16 v[96:99], v[28:31], v[48:51], v[96:99]
    ds_read_b128 v[76:79], v21 offset:32768
    v_mfma_f32_16x16x32_bf16 v[100:103], v[28:31], v[52:55], v[100:103]
    v_mfma_f32_16x16x32_bf16 v[104:107], v[28:31], v[56:59], v[104:107]
    ds_read_b128 v[80:83], v21 offset:34816
    v_mfma_f32_16x16x32_bf16 v[92:95], v[28:31], v[44:47], v[92:95]
    s_waitcnt lgkmcnt(4)
    v_mfma_f32_16x16x32_bf16 v[112:115], v[32:35], v[48:51], v[112:115]
    ds_read_b128 v[84:87], v21 offset:36864
    v_mfma_f32_16x16x32_bf16 v[116:119], v[32:35], v[52:55], v[116:119]
    v_mfma_f32_16x16x32_bf16 v[120:123], v[32:35], v[56:59], v[120:123]
    ds_read_b128 v[88:91], v21 offset:38912
    v_mfma_f32_16x16x32_bf16 v[108:111], v[32:35], v[44:47], v[108:111]
    s_waitcnt lgkmcnt(5)
    v_mfma_f32_16x16x32_bf16 v[128:131], v[36:39], v[48:51], v[128:131]
    ds_read_b128 v[60:63], v17 offset:32768
    v_mfma_f32_16x16x32_bf16 v[132:135], v[36:39], v[52:55], v[132:135]
    v_mfma_f32_16x16x32_bf16 v[136:139], v[36:39], v[56:59], v[136:139]
    ds_read_b128 v[64:67], v17 offset:34816
    v_mfma_f32_16x16x32_bf16 v[124:127], v[36:39], v[44:47], v[124:127]
    s_waitcnt lgkmcnt(6)
    v_mfma_f32_16x16x32_bf16 v[144:147], v[40:43], v[48:51], v[144:147]
    ds_read_b128 v[68:71], v17 offset:36864
    v_mfma_f32_16x16x32_bf16 v[148:151], v[40:43], v[52:55], v[148:151]
    v_mfma_f32_16x16x32_bf16 v[152:155], v[40:43], v[56:59], v[152:155]
    ds_read_b128 v[72:75], v17 offset:38912
    v_mfma_f32_16x16x32_bf16 v[140:143], v[40:43], v[44:47], v[140:143]
    s_barrier
    s_waitcnt lgkmcnt(3)
    v_cndmask_b32 v76, v76, v15, s[68:69]
    v_cndmask_b32 v77, v77, v15, s[68:69]
    v_cndmask_b32 v78, v78, v15, s[68:69]
    v_cndmask_b32 v79, v79, v15, s[68:69]
    v_mfma_f32_16x16x32_bf16 v[96:99], v[60:63], v[80:83], v[96:99]
    ds_read_b128 v[44:47], v24 offset:0
    v_mfma_f32_16x16x32_bf16 v[100:103], v[60:63], v[84:87], v[100:103]
    v_mfma_f32_16x16x32_bf16 v[104:107], v[60:63], v[88:91], v[104:107]
    ds_read_b128 v[48:51], v24 offset:2048
    v_mfma_f32_16x16x32_bf16 v[92:95], v[60:63], v[76:79], v[92:95]
    s_waitcnt lgkmcnt(4)
    v_mfma_f32_16x16x32_bf16 v[112:115], v[64:67], v[80:83], v[112:115]
    ds_read_b128 v[52:55], v24 offset:4096
    v_mfma_f32_16x16x32_bf16 v[116:119], v[64:67], v[84:87], v[116:119]
    v_mfma_f32_16x16x32_bf16 v[120:123], v[64:67], v[88:91], v[120:123]
    ds_read_b128 v[56:59], v24 offset:6144
    v_mfma_f32_16x16x32_bf16 v[108:111], v[64:67], v[76:79], v[108:111]
    s_waitcnt lgkmcnt(5)
    v_mfma_f32_16x16x32_bf16 v[128:131], v[68:71], v[80:83], v[128:131]
    ds_read_b128 v[28:31], v18 offset:0
    v_mfma_f32_16x16x32_bf16 v[132:135], v[68:71], v[84:87], v[132:135]
    v_mfma_f32_16x16x32_bf16 v[136:139], v[68:71], v[88:91], v[136:139]
    ds_read_b128 v[32:35], v18 offset:2048
    v_mfma_f32_16x16x32_bf16 v[124:127], v[68:71], v[76:79], v[124:127]
    s_waitcnt lgkmcnt(6)
    v_mfma_f32_16x16x32_bf16 v[144:147], v[72:75], v[80:83], v[144:147]
    ds_read_b128 v[36:39], v18 offset:4096
    v_mfma_f32_16x16x32_bf16 v[148:151], v[72:75], v[84:87], v[148:151]
    v_mfma_f32_16x16x32_bf16 v[152:155], v[72:75], v[88:91], v[152:155]
    ds_read_b128 v[40:43], v18 offset:6144
    v_mfma_f32_16x16x32_bf16 v[140:143], v[72:75], v[76:79], v[140:143]
    s_waitcnt lgkmcnt(3)
    v_cndmask_b32 v44, v44, v15, s[68:69]
    v_cndmask_b32 v45, v45, v15, s[68:69]
    v_cndmask_b32 v46, v46, v15, s[68:69]
    v_cndmask_b32 v47, v47, v15, s[68:69]
    v_mfma_f32_16x16x32_bf16 v[96:99], v[28:31], v[48:51], v[96:99]
    ds_read_b128 v[76:79], v25 offset:0
    v_mfma_f32_16x16x32_bf16 v[100:103], v[28:31], v[52:55], v[100:103]
    v_mfma_f32_16x16x32_bf16 v[104:107], v[28:31], v[56:59], v[104:107]
    ds_read_b128 v[80:83], v25 offset:2048
    v_mfma_f32_16x16x32_bf16 v[92:95], v[28:31], v[44:47], v[92:95]
    s_waitcnt lgkmcnt(4)
    v_mfma_f32_16x16x32_bf16 v[112:115], v[32:35], v[48:51], v[112:115]
    ds_read_b128 v[84:87], v25 offset:4096
    v_mfma_f32_16x16x32_bf16 v[116:119], v[32:35], v[52:55], v[116:119]
    v_mfma_f32_16x16x32_bf16 v[120:123], v[32:35], v[56:59], v[120:123]
    ds_read_b128 v[88:91], v25 offset:6144
    v_mfma_f32_16x16x32_bf16 v[108:111], v[32:35], v[44:47], v[108:111]
    s_waitcnt lgkmcnt(5)
    v_mfma_f32_16x16x32_bf16 v[128:131], v[36:39], v[48:51], v[128:131]
    ds_read_b128 v[60:63], v19 offset:0
    v_mfma_f32_16x16x32_bf16 v[132:135], v[36:39], v[52:55], v[132:135]
    v_mfma_f32_16x16x32_bf16 v[136:139], v[36:39], v[56:59], v[136:139]
    ds_read_b128 v[64:67], v19 offset:2048
    v_mfma_f32_16x16x32_bf16 v[124:127], v[36:39], v[44:47], v[124:127]
    s_waitcnt lgkmcnt(6)
    v_mfma_f32_16x16x32_bf16 v[144:147], v[40:43], v[48:51], v[144:147]
    ds_read_b128 v[68:71], v19 offset:4096
    v_mfma_f32_16x16x32_bf16 v[148:151], v[40:43], v[52:55], v[148:151]
    v_mfma_f32_16x16x32_bf16 v[152:155], v[40:43], v[56:59], v[152:155]
    ds_read_b128 v[72:75], v19 offset:6144
    v_mfma_f32_16x16x32_bf16 v[140:143], v[40:43], v[44:47], v[140:143]
    s_barrier
    s_waitcnt lgkmcnt(3)
    v_cndmask_b32 v76, v76, v15, s[68:69]
    v_cndmask_b32 v77, v77, v15, s[68:69]
    v_cndmask_b32 v78, v78, v15, s[68:69]
    v_cndmask_b32 v79, v79, v15, s[68:69]
    v_mfma_f32_16x16x32_bf16 v[96:99], v[60:63], v[80:83], v[96:99]
    ds_read_b128 v[44:47], v24 offset:32768
    v_mfma_f32_16x16x32_bf16 v[100:103], v[60:63], v[84:87], v[100:103]
    v_mfma_f32_16x16x32_bf16 v[104:107], v[60:63], v[88:91], v[104:107]
    ds_read_b128 v[48:51], v24 offset:34816
    v_mfma_f32_16x16x32_bf16 v[92:95], v[60:63], v[76:79], v[92:95]
    s_waitcnt lgkmcnt(4)
    v_mfma_f32_16x16x32_bf16 v[112:115], v[64:67], v[80:83], v[112:115]
    ds_read_b128 v[52:55], v24 offset:36864
    v_mfma_f32_16x16x32_bf16 v[116:119], v[64:67], v[84:87], v[116:119]
    v_mfma_f32_16x16x32_bf16 v[120:123], v[64:67], v[88:91], v[120:123]
    ds_read_b128 v[56:59], v24 offset:38912
    v_mfma_f32_16x16x32_bf16 v[108:111], v[64:67], v[76:79], v[108:111]
    s_waitcnt lgkmcnt(5)
    v_mfma_f32_16x16x32_bf16 v[128:131], v[68:71], v[80:83], v[128:131]
    ds_read_b128 v[28:31], v18 offset:32768
    v_mfma_f32_16x16x32_bf16 v[132:135], v[68:71], v[84:87], v[132:135]
    v_mfma_f32_16x16x32_bf16 v[136:139], v[68:71], v[88:91], v[136:139]
    ds_read_b128 v[32:35], v18 offset:34816
    v_mfma_f32_16x16x32_bf16 v[124:127], v[68:71], v[76:79], v[124:127]
    s_waitcnt lgkmcnt(6)
    v_mfma_f32_16x16x32_bf16 v[144:147], v[72:75], v[80:83], v[144:147]
    ds_read_b128 v[36:39], v18 offset:36864
    v_mfma_f32_16x16x32_bf16 v[148:151], v[72:75], v[84:87], v[148:151]
    v_mfma_f32_16x16x32_bf16 v[152:155], v[72:75], v[88:91], v[152:155]
    ds_read_b128 v[40:43], v18 offset:38912
    v_mfma_f32_16x16x32_bf16 v[140:143], v[72:75], v[76:79], v[140:143]
    s_cmp_lg_u32 s21, 0
    s_cbranch_scc1 L_k1a_last
    s_waitcnt lgkmcnt(3)
    v_cndmask_b32 v44, v44, v15, s[68:69]
    v_cndmask_b32 v45, v45, v15, s[68:69]
    v_cndmask_b32 v46, v46, v15, s[68:69]
    v_cndmask_b32 v47, v47, v15, s[68:69]
    v_mfma_f32_16x16x32_bf16 v[96:99], v[28:31], v[48:51], v[96:99]
    ds_read_b128 v[76:79], v25 offset:32768
    v_mfma_f32_16x16x32_bf16 v[100:103], v[28:31], v[52:55], v[100:103]
    v_mfma_f32_16x16x32_bf16 v[104:107], v[28:31], v[56:59], v[104:107]
    ds_read_b128 v[80:83], v25 offset:34816
    v_mfma_f32_16x16x32_bf16 v[92:95], v[28:31], v[44:47], v[92:95]
    s_waitcnt lgkmcnt(4)
    v_mfma_f32_16x16x32_bf16 v[112:115], v[32:35], v[48:51], v[112:115]
    ds_read_b128 v[84:87], v25 offset:36864
    v_mfma_f32_16x16x32_bf16 v[116:119], v[32:35], v[52:55], v[116:119]
    v_mfma_f32_16x16x32_bf16 v[120:123], v[32:35], v[56:59], v[120:123]
    ds_read_b128 v[88:91], v25 offset:38912
    v_mfma_f32_16x16x32_bf16 v[108:111], v[32:35], v[44:47], v[108:111]
    s_waitcnt lgkmcnt(5)
    v_mfma_f32_16x16x32_bf16 v[128:131], v[36:39], v[48:51], v[128:131]
    ds_read_b128 v[60:63], v19 offset:32768
    v_mfma_f32_16x16x32_bf16 v[132:135], v[36:39], v[52:55], v[132:135]
    v_mfma_f32_16x16x32_bf16 v[136:139], v[36:39], v[56:59], v[136:139]
    ds_read_b128 v[64:67], v19 offset:34816
    v_mfma_f32_16x16x32_bf16 v[124:127], v[36:39], v[44:47], v[124:127]
    s_waitcnt lgkmcnt(6)
    v_mfma_f32_16x16x32_bf16 v[144:147], v[40:43], v[48:51], v[144:147]
    ds_read_b128 v[68:71], v19 offset:36864
    v_mfma_f32_16x16x32_bf16 v[148:151], v[40:43], v[52:55], v[148:151]
    v_mfma_f32_16x16x32_bf16 v[152:155], v[40:43], v[56:59], v[152:155]
    ds_read_b128 v[72:75], v19 offset:38912
    v_mfma_f32_16x16x32_bf16 v[140:143], v[40:43], v[44:47], v[140:143]
    s_barrier
    s_waitcnt lgkmcnt(3)
    v_cndmask_b32 v76, v76, v15, s[68:69]
    v_cndmask_b32 v77, v77, v15, s[68:69]
    v_cndmask_b32 v78, v78, v15, s[68:69]
    v_cndmask_b32 v79, v79, v15, s[68:69]
    v_mfma_f32_16x16x32_bf16 v[96:99], v[60:63], v[80:83], v[96:99]
    ds_read_b128 v[44:47], v20 offset:0
    v_mfma_f32_16x16x32_bf16 v[100:103], v[60:63], v[84:87], v[100:103]
    v_mfma_f32_16x16x32_bf16 v[104:107], v[60:63], v[88:91], v[104:107]
    ds_read_b128 v[48:51], v20 offset:2048
    v_mfma_f32_16x16x32_bf16 v[92:95], v[60:63], v[76:79], v[92:95]
    s_waitcnt lgkmcnt(4)
    v_mfma_f32_16x16x32_bf16 v[112:115], v[64:67], v[80:83], v[112:115]
    ds_read_b128 v[52:55], v20 offset:4096
    v_mfma_f32_16x16x32_bf16 v[116:119], v[64:67], v[84:87], v[116:119]
    v_mfma_f32_16x16x32_bf16 v[120:123], v[64:67], v[88:91], v[120:123]
    ds_read_b128 v[56:59], v20 offset:6144
    v_mfma_f32_16x16x32_bf16 v[108:111], v[64:67], v[76:79], v[108:111]
    s_waitcnt lgkmcnt(5)
    v_mfma_f32_16x16x32_bf16 v[128:131], v[68:71], v[80:83], v[128:131]
    ds_read_b128 v[28:31], v16 offset:0
    v_mfma_f32_16x16x32_bf16 v[132:135], v[68:71], v[84:87], v[132:135]
    v_mfma_f32_16x16x32_bf16 v[136:139], v[68:71], v[88:91], v[136:139]
    ds_read_b128 v[32:35], v16 offset:2048
    v_mfma_f32_16x16x32_bf16 v[124:127], v[68:71], v[76:79], v[124:127]
    s_waitcnt lgkmcnt(6)
    v_mfma_f32_16x16x32_bf16 v[144:147], v[72:75], v[80:83], v[144:147]
    ds_read_b128 v[36:39], v16 offset:4096
    v_mfma_f32_16x16x32_bf16 v[148:151], v[72:75], v[84:87], v[148:151]
    v_mfma_f32_16x16x32_bf16 v[152:155], v[72:75], v[88:91], v[152:155]
    ds_read_b128 v[40:43], v16 offset:6144
    v_mfma_f32_16x16x32_bf16 v[140:143], v[72:75], v[76:79], v[140:143]
    s_mov_b32 s21, 1
    s_branch L_k1a_loop
L_k1a_last:
    s_waitcnt lgkmcnt(3)
    v_cndmask_b32 v44, v44, v15, s[68:69]
    v_cndmask_b32 v45, v45, v15, s[68:69]
    v_cndmask_b32 v46, v46, v15, s[68:69]
    v_cndmask_b32 v47, v47, v15, s[68:69]
    v_mfma_f32_16x16x32_bf16 v[96:99], v[28:31], v[48:51], v[96:99]
    ds_read_b128 v[76:79], v25 offset:32768
    v_mfma_f32_16x16x32_bf16 v[100:103], v[28:31], v[52:55], v[100:103]
    v_mfma_f32_16x16x32_bf16 v[104:107], v[28:31], v[56:59], v[104:107]
    ds_read_b128 v[80:83], v25 offset:34816
    v_mfma_f32_16x16x32_bf16 v[92:95], v[28:31], v[44:47], v[92:95]
    s_waitcnt lgkmcnt(4)
    v_mfma_f32_16x16x32_bf16 v[112:115], v[32:35], v[48:51], v[112:115]
    ds_read_b128 v[84:87], v25 offset:36864
    v_mfma_f32_16x16x32_bf16 v[116:119], v[32:35], v[52:55], v[116:119]
    v_mfma_f32_16x16x32_bf16 v[120:123], v[32:35], v[56:59], v[120:123]
    ds_read_b128 v[88:91], v25 offset:38912
    v_mfma_f32_16x16x32_bf16 v[108:111], v[32:35], v[44:47], v[108:111]
    s_waitcnt lgkmcnt(5)
    v_mfma_f32_16x16x32_bf16 v[128:131], v[36:39], v[48:51], v[128:131]
    ds_read_b128 v[60:63], v19 offset:32768
    v_mfma_f32_16x16x32_bf16 v[132:135], v[36:39], v[52:55], v[132:135]
    v_mfma_f32_16x16x32_bf16 v[136:139], v[36:39], v[56:59], v[136:139]
    ds_read_b128 v[64:67], v19 offset:34816
    v_mfma_f32_16x16x32_bf16 v[124:127], v[36:39], v[44:47], v[124:127]
    s_waitcnt lgkmcnt(6)
    v_mfma_f32_16x16x32_bf16 v[144:147], v[40:43], v[48:51], v[144:147]
    ds_read_b128 v[68:71], v19 offset:36864
    v_mfma_f32_16x16x32_bf16 v[148:151], v[40:43], v[52:55], v[148:151]
    v_mfma_f32_16x16x32_bf16 v[152:155], v[40:43], v[56:59], v[152:155]
    ds_read_b128 v[72:75], v19 offset:38912
    v_mfma_f32_16x16x32_bf16 v[140:143], v[40:43], v[44:47], v[140:143]
    s_waitcnt lgkmcnt(3)
    v_cndmask_b32 v76, v76, v15, s[68:69]
    v_cndmask_b32 v77, v77, v15, s[68:69]
    v_cndmask_b32 v78, v78, v15, s[68:69]
    v_cndmask_b32 v79, v79, v15, s[68:69]
    v_mfma_f32_16x16x32_bf16 v[96:99], v[60:63], v[80:83], v[96:99]
    v_mfma_f32_16x16x32_bf16 v[100:103], v[60:63], v[84:87], v[100:103]
    v_mfma_f32_16x16x32_bf16 v[104:107], v[60:63], v[88:91], v[104:107]
    v_mfma_f32_16x16x32_bf16 v[92:95], v[60:63], v[76:79], v[92:95]
    s_waitcnt lgkmcnt(2)
    v_mfma_f32_16x16x32_bf16 v[112:115], v[64:67], v[80:83], v[112:115]
    v_mfma_f32_16x16x32_bf16 v[116:119], v[64:67], v[84:87], v[116:119]
    v_mfma_f32_16x16x32_bf16 v[120:123], v[64:67], v[88:91], v[120:123]
    v_mfma_f32_16x16x32_bf16 v[108:111], v[64:67], v[76:79], v[108:111]
    s_waitcnt lgkmcnt(1)
    v_mfma_f32_16x16x32_bf16 v[128:131], v[68:71], v[80:83], v[128:131]
    v_mfma_f32_16x16x32_bf16 v[132:135], v[68:71], v[84:87], v[132:135]
    v_mfma_f32_16x16x32_bf16 v[136:139], v[68:71], v[88:91], v[136:139]
    v_mfma_f32_16x16x32_bf16 v[124:127], v[68:71], v[76:79], v[124:127]
    s_waitcnt lgkmcnt(0)
    v_mfma_f32_16x16x32_bf16 v[144:147], v[72:75], v[80:83], v[144:147]
    s_waitcnt lgkmcnt(0)
    s_barrier
    ds_read_b32 v160, v5 offset:0
    ds_read_b32 v164, v5 offset:64
    ds_read_b32 v168, v5 offset:128
    ds_read_b32 v172, v5 offset:192
    ds_read_b32 v14, v7
    ds_read_b128 v[28:31], v6 offset:0
    ds_read_b128 v[44:47], v6 offset:256
    ds_read_b128 v[32:35], v6 offset:64
    ds_read_b128 v[48:51], v6 offset:320
    ds_read_b128 v[36:39], v6 offset:128
    ds_read_b128 v[52:55], v6 offset:384
    ds_read_b128 v[40:43], v6 offset:192
    ds_read_b128 v[56:59], v6 offset:448
    v_mfma_f32_16x16x32_bf16 v[148:151], v[72:75], v[84:87], v[148:151]
    v_mfma_f32_16x16x32_bf16 v[152:155], v[72:75], v[88:91], v[152:155]
    v_mfma_f32_16x16x32_bf16 v[140:143], v[72:75], v[76:79], v[140:143]
    s_setprio 2
    s_waitcnt vmcnt(0) lgkmcnt(0)
    v_readfirstlane_b32 s63, v14
    s_nop 3
    s_cmp_ge_u32 s29, 2
    s_cselect_b32 s22, 0xbf800000, 1.0
    v_mov_b32 v185, s22
    s_cmp_eq_u32 s35, 0
    s_cselect_b32 s68, s68, 0
    s_cselect_b32 s69, s69, 0
    v_cndmask_b32 v184, v185, 1.0, s[68:69]
    v_pk_mul_f32 v[76:77], v[44:45], v[160:161] op_sel_hi:[1,0]
    v_pk_mul_f32 v[78:79], v[46:47], v[160:161] op_sel_hi:[1,0]
    v_pk_fma_f32 v[92:93], v[28:29], v[92:93], v[76:77] neg_lo:[0,0,1] neg_hi:[0,0,1]
    v_pk_fma_f32 v[94:95], v[30:31], v[94:95], v[78:79] neg_lo:[0,0,1] neg_hi:[0,0,1]
    v_pk_mul_f32 v[80:81], v[48:49], v[160:161] op_sel_hi:[1,0]
    v_pk_mul_f32 v[82:83], v[50:51], v[160:161] op_sel_hi:[1,0]
    v_pk_fma_f32 v[108:109], v[32:33], v[108:109], v[80:81] neg_lo:[0,0,1] neg_hi:[0,0,1]
    v_pk_fma_f32 v[110:111], v[34:35], v[110:111], v[82:83] neg_lo:[0,0,1] neg_hi:[0,0,1]
    v_pk_mul_f32 v[76:77], v[52:53], v[160:161] op_sel_hi:[1,0]
    v_pk_mul_f32 v[78:79], v[54:55], v[160:161] op_sel_hi:[1,0]
    v_pk_fma_f32 v[124:125], v[36:37], v[124:125], v[76:77] neg_lo:[0,0,1] neg_hi:[0,0,1]
    v_pk_fma_f32 v[126:127], v[38:39], v[126:127], v[78:79] neg_lo:[0,0,1] neg_hi:[0,0,1]
    v_pk_mul_f32 v[80:81], v[56:57], v[160:161] op_sel_hi:[1,0]
    v_pk_mul_f32 v[82:83], v[58:59], v[160:161] op_sel_hi:[1,0]
    v_pk_fma_f32 v[140:141], v[40:41], v[140:141], v[80:81] neg_lo:[0,0,1] neg_hi:[0,0,1]
    v_pk_fma_f32 v[142:143], v[42:43], v[142:143], v[82:83] neg_lo:[0,0,1] neg_hi:[0,0,1]
    v_pk_mul_f32 v[76:77], v[44:45], v[164:165] op_sel_hi:[1,0]
    v_pk_mul_f32 v[78:79], v[46:47], v[164:165] op_sel_hi:[1,0]
    v_pk_fma_f32 v[96:97], v[28:29], v[96:97], v[76:77] neg_lo:[0,0,1] neg_hi:[0,0,1]
    v_pk_fma_f32 v[98:99], v[30:31], v[98:99], v[78:79] neg_lo:[0,0,1] neg_hi:[0,0,1]
    v_pk_mul_f32 v[80:81], v[48:49], v[164:165] op_sel_hi:[1,0]
    v_pk_mul_f32 v[82:83], v[50:51], v[164:165] op_sel_hi:[1,0]
    v_pk_fma_f32 v[112:113], v[32:33], v[112:113], v[80:81] neg_lo:[0,0,1] neg_hi:[0,0,1]
    v_pk_fma_f32 v[114:115], v[34:35], v[114:115], v[82:83] neg_lo:[0,0,1] neg_hi:[0,0,1]
    v_pk_mul_f32 v[76:77], v[52:53], v[164:165] op_sel_hi:[1,0]
    v_pk_mul_f32 v[78:79], v[54:55], v[164:165] op_sel_hi:[1,0]
    v_pk_fma_f32 v[128:129], v[36:37], v[128:129], v[76:77] neg_lo:[0,0,1] neg_hi:[0,0,1]
    v_pk_fma_f32 v[130:131], v[38:39], v[130:131], v[78:79] neg_lo:[0,0,1] neg_hi:[0,0,1]
    v_pk_mul_f32 v[80:81], v[56:57], v[164:165] op_sel_hi:[1,0]
    v_pk_mul_f32 v[82:83], v[58:59], v[164:165] op_sel_hi:[1,0]
    v_pk_fma_f32 v[144:145], v[40:41], v[144:145], v[80:81] neg_lo:[0,0,1] neg_hi:[0,0,1]
    v_pk_fma_f32 v[146:147], v[42:43], v[146:147], v[82:83] neg_lo:[0,0,1] neg_hi:[0,0,1]
    v_pk_mul_f32 v[76:77], v[44:45], v[168:169] op_sel_hi:[1,0]
    v_pk_mul_f32 v[78:79], v[46:47], v[168:169] op_sel_hi:[1,0]
    v_pk_fma_f32 v[100:101], v[28:29], v[100:101], v[76:77] neg_lo:[0,0,1] neg_hi:[0,0,1]
    v_pk_fma_f32 v[102:103], v[30:31], v[102:103], v[78:79] neg_lo:[0,0,1] neg_hi:[0,0,1]
    v_pk_mul_f32 v[80:81], v[48:49], v[168:169] op_sel_hi:[1,0]
    v_pk_mul_f32 v[82:83], v[50:51], v[168:169] op_sel_hi:[1,0]
    v_pk_fma_f32 v[116:117], v[32:33], v[116:117], v[80:81] neg_lo:[0,0,1] neg_hi:[0,0,1]
    v_pk_fma_f32 v[118:119], v[34:35], v[118:119], v[82:83] neg_lo:[0,0,1] neg_hi:[0,0,1]
    v_pk_mul_f32 v[76:77], v[52:53], v[168:169] op_sel_hi:[1,0]
    v_pk_mul_f32 v[78:79], v[54:55], v[168:169] op_sel_hi:[1,0]
    v_pk_fma_f32 v[132:133], v[36:37], v[132:133], v[76:77] neg_lo:[0,0,1] neg_hi:[0,0,1]
    v_pk_fma_f32 v[134:135], v[38:39], v[134:135], v[78:79] neg_lo:[0,0,1] neg_hi:[0,0,1]
    v_pk_mul_f32 v[80:81], v[56:57], v[168:169] op_sel_hi:[1,0]
    v_pk_mul_f32 v[82:83], v[58:59], v[168:169] op_sel_hi:[1,0]
    v_pk_fma_f32 v[148:149], v[40:41], v[148:149], v[80:81] neg_lo:[0,0,1] neg_hi:[0,0,1]
    v_pk_fma_f32 v[150:151], v[42:43], v[150:151], v[82:83] neg_lo:[0,0,1] neg_hi:[0,0,1]
    v_pk_mul_f32 v[76:77], v[44:45], v[172:173] op_sel_hi:[1,0]
    v_pk_mul_f32 v[78:79], v[46:47], v[172:173] op_sel_hi:[1,0]
    v_pk_fma_f32 v[104:105], v[28:29], v[104:105], v[76:77] neg_lo:[0,0,1] neg_hi:[0,0,1]
    v_pk_fma_f32 v[106:107], v[30:31], v[106:107], v[78:79] neg_lo:[0,0,1] neg_hi:[0,0,1]
    v_pk_mul_f32 v[80:81], v[48:49], v[172:173] op_sel_hi:[1,0]
    v_pk_mul_f32 v[82:83], v[50:51], v[172:173] op_sel_hi:[1,0]
    v_pk_fma_f32 v[120:121], v[32:33], v[120:121], v[80:81] neg_lo:[0,0,1] neg_hi:[0,0,1]
    v_pk_fma_f32 v[122:123], v[34:35], v[122:123], v[82:83] neg_lo:[0,0,1] neg_hi:[0,0,1]
    v_pk_mul_f32 v[76:77], v[52:53], v[172:173] op_sel_hi:[1,0]
    v_pk_mul_f32 v[78:79], v[54:55], v[172:173] op_sel_hi:[1,0]
    v_pk_fma_f32 v[136:137], v[36:37], v[136:137], v[76:77] neg_lo:[0,0,1] neg_hi:[0,0,1]
    v_pk_fma_f32 v[138:139], v[38:39], v[138:139], v[78:79] neg_lo:[0,0,1] neg_hi:[0,0,1]
    v_pk_mul_f32 v[80:81], v[56:57], v[172:173] op_sel_hi:[1,0]
    v_pk_mul_f32 v[82:83], v[58:59], v[172:173] op_sel_hi:[1,0]
    v_pk_fma_f32 v[152:153], v[40:41], v[152:153], v[80:81] neg_lo:[0,0,1] neg_hi:[0,0,1]
    v_pk_fma_f32 v[154:155], v[42:43], v[154:155], v[82:83] neg_lo:[0,0,1] neg_hi:[0,0,1]
    s_or_b32 s22, s28, s34
    s_cmp_lg_u32 s22, 0
    s_cbranch_scc1 L_k1a_nosp
    s_lshl_b32 s22, s29, 9
    s_lshl_b32 s23, s35, 8
    s_add_u32 s22, s22, s23
    s_add_u32 s22, s22, 14680064
    s_mov_b64 exec, 0xffff
    v_fma_f32 v76, v184, v140, v108
    v_mov_b32 v108, 0
    v_mov_b32 v140, 0
    buffer_store_dword v76, v4, s[24:27], s22 offen offset:0 sc1
    v_fma_f32 v77, v185, v144, v112
    v_mov_b32 v112, 0
    v_mov_b32 v144, 0
    buffer_store_dword v77, v4, s[24:27], s22 offen offset:64 sc1
    v_fma_f32 v78, v185, v148, v116
    v_mov_b32 v116, 0
    v_mov_b32 v148, 0
    buffer_store_dword v78, v4, s[24:27], s22 offen offset:128 sc1
    v_fma_f32 v79, v185, v152, v120
    v_mov_b32 v120, 0
    v_mov_b32 v152, 0
    buffer_store_dword v79, v4, s[24:27], s22 offen offset:192 sc1
    s_mov_b64 exec, -1
L_k1a_nosp:
    v_lshlrev_b32 v5, 4, v1
    s_lshl_b32 s22, s34, 10
    v_add_u32 v5, s22, v5
    s_and_b32 s22, s29, 1
    s_lshl_b32 s22, s22, 2
    s_lshl_b32 s23, s35, 1
    s_add_u32 s22, s22, s23
    s_lshl_b32 s22, s22, 16
    s_lshl_b32 s23, s28, 12
    s_add_u32 s22, s22, s23
    s_lshr_b32 s23, s29, 1
    s_lshl_b32 s23, s23, 11
    s_add_u32 s22, s22, s23
    s_add_u32 s22, s22, 12582912
    s_add_u32 s23, s22, 524288
    s_add_u32 s31, s22, 65536
    s_add_u32 s32, s23, 65536
    v_pk_fma_f32 v[92:93], v[184:185], v[108:109], v[92:93] op_sel:[0,0,0] op_sel_hi:[0,1,1]
    v_pk_fma_f32 v[124:125], v[184:185], v[140:141], v[124:125] op_sel:[0,0,0] op_sel_hi:[0,1,1]
    v_pk_fma_f32 v[94:95], v[184:185], v[110:111], v[94:95] op_sel:[0,0,0] op_sel_hi:[0,1,1]
    v_pk_fma_f32 v[126:127], v[184:185], v[142:143], v[126:127] op_sel:[0,0,0] op_sel_hi:[0,1,1]
    v_pk_fma_f32 v[108:109], v[184:185], v[124:125], v[92:93] op_sel:[0,0,0] op_sel_hi:[0,1,1]
    v_pk_fma_f32 v[140:141], v[184:185], v[124:125], v[92:93] op_sel:[0,0,0] op_sel_hi:[0,1,1] neg_lo:[1,0,0] neg_hi:[1,0,0]
    v_pk_fma_f32 v[110:111], v[184:185], v[126:127], v[94:95] op_sel:[0,0,0] op_sel_hi:[0,1,1]
    v_pk_fma_f32 v[142:143], v[184:185], v[126:127], v[94:95] op_sel:[0,0,0] op_sel_hi:[0,1,1] neg_lo:[1,0,0] neg_hi:[1,0,0]
    v_cvt_pk_bf16_f32 v108, v108, v109
    v_cvt_pk_bf16_f32 v109, v110, v111
    v_cvt_pk_bf16_f32 v140, v140, v141
    v_cvt_pk_bf16_f32 v141, v142, v143
    s_cmp_eq_u32 s68, 0
    s_cbranch_scc1 L_k1a_nbx
    s_lshl_b32 s33, s28, 6
    s_lshl_b32 s57, s34, 3
    s_add_u32 s33, s33, s57
    s_add_u32 s33, s33, 14688256
    s_mov_b64 exec, s[68:69]
    buffer_store_dwordx2 v[108:109], v1, s[24:27], s33 offen sc1
    buffer_store_dwordx2 v[140:141], v1, s[24:27], s33 offen offset:1024 sc1
    s_mov_b64 exec, -1
L_k1a_nbx:
    v_pk_fma_f32 v[96:97], v[184:185], v[112:113], v[96:97] op_sel:[1,0,0] op_sel_hi:[1,1,1]
    v_pk_fma_f32 v[128:129], v[184:185], v[144:145], v[128:129] op_sel:[1,0,0] op_sel_hi:[1,1,1]
    v_pk_fma_f32 v[98:99], v[184:185], v[114:115], v[98:99] op_sel:[1,0,0] op_sel_hi:[1,1,1]
    v_pk_fma_f32 v[130:131], v[184:185], v[146:147], v[130:131] op_sel:[1,0,0] op_sel_hi:[1,1,1]
    v_pk_fma_f32 v[112:113], v[184:185], v[128:129], v[96:97] op_sel:[1,0,0] op_sel_hi:[1,1,1]
    v_pk_fma_f32 v[144:145], v[184:185], v[128:129], v[96:97] op_sel:[1,0,0] op_sel_hi:[1,1,1] neg_lo:[1,0,0] neg_hi:[1,0,0]
    v_pk_fma_f32 v[114:115], v[184:185], v[130:131], v[98:99] op_sel:[1,0,0] op_sel_hi:[1,1,1]
    v_pk_fma_f32 v[146:147], v[184:185], v[130:131], v[98:99] op_sel:[1,0,0] op_sel_hi:[1,1,1] neg_lo:[1,0,0] neg_hi:[1,0,0]
    v_cvt_pk_bf16_f32 v110, v112, v113
    v_cvt_pk_bf16_f32 v111, v114, v115
    v_cvt_pk_bf16_f32 v142, v144, v145
    v_cvt_pk_bf16_f32 v143, v146, v147
    buffer_store_dwordx4 v[108:111], v5, s[24:27], s22 offen sc1
    buffer_store_dwordx4 v[140:143], v5, s[24:27], s23 offen sc1
    v_pk_fma_f32 v[100:101], v[184:185], v[116:117], v[100:101] op_sel:[1,0,0] op_sel_hi:[1,1,1]
    v_pk_fma_f32 v[132:133], v[184:185], v[148:149], v[132:133] op_sel:[1,0,0] op_sel_hi:[1,1,1]
    v_pk_fma_f32 v[102:103], v[184:185], v[118:119], v[102:103] op_sel:[1,0,0] op_sel_hi:[1,1,1]
    v_pk_fma_f32 v[134:135], v[184:185], v[150:151], v[134:135] op_sel:[1,0,0] op_sel_hi:[1,1,1]
    v_pk_fma_f32 v[116:117], v[184:185], v[132:133], v[100:101] op_sel:[1,0,0] op_sel_hi:[1,1,1]
    v_pk_fma_f32 v[148:149], v[184:185], v[132:133], v[100:101] op_sel:[1,0,0] op_sel_hi:[1,1,1] neg_lo:[1,0,0] neg_hi:[1,0,0]
    v_pk_fma_f32 v[118:119], v[184:185], v[134:135], v[102:103] op_sel:[1,0,0] op_sel_hi:[1,1,1]
    v_pk_fma_f32 v[150:151], v[184:185], v[134:135], v[102:103] op_sel:[1,0,0] op_sel_hi:[1,1,1] neg_lo:[1,0,0] neg_hi:[1,0,0]
    v_cvt_pk_bf16_f32 v116, v116, v117
    v_cvt_pk_bf16_f32 v117, v118, v119
    v_cvt_pk_bf16_f32 v148, v148, v149
    v_cvt_pk_bf16_f32 v149, v150, v151
    v_pk_fma_f32 v[104:105], v[184:185], v[120:121], v[104:105] op_sel:[1,0,0] op_sel_hi:[1,1,1]
    v_pk_fma_f32 v[136:137], v[184:185], v[152:153], v[136:137] op_sel:[1,0,0] op_sel_hi:[1,1,1]
    v_pk_fma_f32 v[106:107], v[184:185], v[122:123], v[106:107] op_sel:[1,0,0] op_sel_hi:[1,1,1]
    v_pk_fma_f32 v[138:139], v[184:185], v[154:155], v[138:139] op_sel:[1,0,0] op_sel_hi:[1,1,1]
    v_pk_fma_f32 v[120:121], v[184:185], v[136:137], v[104:105] op_sel:[1,0,0] op_sel_hi:[1,1,1]
    v_pk_fma_f32 v[152:153], v[184:185], v[136:137], v[104:105] op_sel:[1,0,0] op_sel_hi:[1,1,1] neg_lo:[1,0,0] neg_hi:[1,0,0]
    v_pk_fma_f32 v[122:123], v[184:185], v[138:139], v[106:107] op_sel:[1,0,0] op_sel_hi:[1,1,1]
    v_pk_fma_f32 v[154:155], v[184:185], v[138:139], v[106:107] op_sel:[1,0,0] op_sel_hi:[1,1,1] neg_lo:[1,0,0] neg_hi:[1,0,0]
    v_cvt_pk_bf16_f32 v118, v120, v121
    v_cvt_pk_bf16_f32 v119, v122, v123
    v_cvt_pk_bf16_f32 v150, v152, v153
    v_cvt_pk_bf16_f32 v151, v154, v155
    buffer_store_dwordx4 v[116:119], v5, s[24:27], s31 offen sc1
    buffer_store_dwordx4 v[148:151], v5, s[24:27], s32 offen sc1
    v_and_b32 v1, 63, v0
    v_mov_b32 v3, s63
    v_lshlrev_b32 v2, 10, v1
    s_waitcnt vmcnt(0)
    s_mov_b64 exec, 0xffffffff
    buffer_store_dword v3, v2, s[24:27], s55 offen sc1
    s_mov_b64 exec, -1
    s_branch L_p2_pq
L_k1_typeB:
    s_mov_b32 s12, s48
    s_mov_b32 s13, s49
    s_mov_b32 s14, 1409024
    s_mov_b32 s15, 0x20000
    s_mov_b32 s36, s50
    s_mov_b32 s37, s51
    s_mov_b32 s38, 2752
    s_mov_b32 s39, 0x20000
    s_and_b32 s22, s28, 1
    s_mul_i32 s23, s22, 6
    s_lshr_b32 s30, s29, 2
    s_add_u32 s30, s30, s23
    s_lshl_b32 s22, s22, 1
    s_add_u32 s22, s22, s29
    s_cmp_ge_u32 s29, 20
    s_cselect_b32 s30, 5, s30
    s_cselect_b32 s29, s22, s29
    s_and_b32 s43, s29, 3
    s_lshl_b32 s30, s30, 7
    s_lshl_b32 s18, s30, 1
    s_and_b32 s23, s29, 2
    s_and_b32 s29, s29, 1
    s_and_b32 s28, s28, 6
    s_sub_u32 s22, 14, s28
    s_cmp_eq_u32 s23, 0
    s_cselect_b32 s28, s28, s22
    s_and_b32 s23, s16, 1
    s_lshl_b32 s23, s23, 6
    s_add_u32 s33, s30, s23
    v_and_b32 v1, 63, v0
    v_lshrrev_b32 v3, 4, v1
    v_lshlrev_b32 v12, 3, v3
    s_lshl_b32 s33, s33, 1
    s_lshl_b32 s55, s29, 4
    s_add_u32 s55, s55, s28
    s_lshr_b32 s23, s16, 1
    s_add_u32 s55, s55, s23
    s_mul_i32 s55, s55, 2048
    s_lshr_b32 s23, s33, 4
    s_add_u32 s55, s55, s23
    s_add_u32 s55, s55, 15728640
    s_cmp_eq_u32 s53, 0
    s_cbranch_scc1 L_k1b_cons
    s_setprio 1
    v_and_b32 v1, 63, v0
    v_lshrrev_b32 v2, 3, v1
    v_lshrrev_b32 v3, 4, v1
    v_and_b32 v4, 7, v1
    v_xor_b32 v8, v3, v4
    s_and_b32 s22, s16, 1
    s_lshl_b32 s22, s22, 2
    v_xor_b32 v8, s22, v8
    v_lshlrev_b32 v8, 4, v8
    s_lshr_b32 s22, s30, 7
    s_mul_i32 s23, s43, 2
    s_add_u32 s22, s22, s23
    s_and_b32 s56, s22, 7
    s_lshl_b32 s17, s56, 7
    s_mul_i32 s23, s56, 176128
    s_add_u32 s18, s18, s23
    s_lshl_b32 s19, s16, 10
    s_lshr_b32 s22, s16, 1
    s_lshl_b32 s22, s22, 3
    v_lshlrev_b32 v6, 1, v3
    v_and_b32 v7, 15, v1
    v_xor_b32 v6, v6, v7
    v_xor_b32 v6, s22, v6
    v_mul_u32_u24 v5, 2752, v3
    s_lshr_b32 s22, s30, 3
    v_mov_b32 v7, 0x40000000
    v_lshl_add_u32 v10, v6, 4, v5
    v_add_u32 v4, s22, v6
    v_cmp_gt_u32 vcc, 172, v4
    s_mul_i32 s22, s16, 11008
    s_add_u32 s18, s18, s22
    v_cndmask_b32 v10, v7, v10, vcc
    s_add_u32 m0, s19, 16384
    s_add_u32 s22, s18, 0
    buffer_load_dwordx4 v10, s[12:15], s22 offen lds
    s_add_u32 m0, s19, 20480
    s_add_u32 s22, s18, 44032
    buffer_load_dwordx4 v10, s[12:15], s22 offen lds
    s_add_u32 m0, s19, 24576
    s_add_u32 s22, s18, 88064
    buffer_load_dwordx4 v10, s[12:15], s22 offen lds
    s_add_u32 m0, s19, 28672
    s_add_u32 s22, s18, 132096
    buffer_load_dwordx4 v10, s[12:15], s22 offen lds
    s_lshl_b32 s22, s28, 6
    s_add_u32 s22, s22, s29
    s_lshl_b32 s23, s16, 4
    s_add_u32 s22, s22, s23
    v_lshl_add_u32 v5, v2, 1, s22
    v_cmp_eq_u32 vcc, 0, v5
    v_lshl_add_u32 v13, v5, 10, v8
    v_sub_u32 v5, 2048, v5
    v_add_u32 v15, 65536, v13
    v_lshl_add_u32 v16, v5, 10, v8
    v_mov_b32 v6, 1024
    v_cndmask_b32 v5, v5, v6, vcc
    v_subrev_u32 v16, 65536, v16
    v_lshl_add_u32 v14, v5, 10, v8
    s_add_u32 m0, s19, 0
    s_nop 0
    buffer_load_dwordx4 v13, s[8:11], s17 offen lds
    s_add_u32 m0, s19, 4096
    s_nop 0
    buffer_load_dwordx4 v14, s[8:11], s17 offen lds
    s_add_u32 m0, s19, 8192
    s_nop 0
    buffer_load_dwordx4 v15, s[8:11], s17 offen lds
    s_add_u32 m0, s19, 12288
    s_nop 0
    buffer_load_dwordx4 v16, s[8:11], s17 offen lds
    s_add_u32 s17, s17, 128
    s_add_u32 s18, s18, 176128
    s_cmp_eq_u32 s17, 1024
    s_cselect_b32 s17, 0, s17
    s_cselect_b32 s22, 1409024, 0
    s_sub_u32 s18, s18, s22
    s_and_b32 s40, s2, 6
    s_sub_u32 s41, 12, s40
    s_cmp_lt_u32 s2, 128
    s_cselect_b32 s40, s40, s41
    s_lshr_b32 s41, s2, 6
    s_add_u32 s40, s40, s41
    s_lshl_b32 s40, s40, 1
    s_and_b32 s41, s2, 1
    s_add_u32 s40, s40, s41
    s_lshl_b32 s40, s40, 3
    s_bfe_u32 s41, s2, 0x30003
    s_add_u32 s40, s40, s41
    s_lshl_b32 s40, s40, 2
    s_add_u32 s40, s40, s16
    s_sub_u32 s41, 2048, s40
    s_cmp_eq_u32 s40, 0
    s_cselect_b32 s41, 1024, s41
    v_lshlrev_b32 v240, 4, v1
    s_lshl_b32 s22, s40, 10
    s_lshl_b32 s23, s41, 10
    buffer_load_dwordx4 v[216:219], v240, s[8:11], s22 offen
    buffer_load_dwordx4 v[220:223], v240, s[8:11], s23 offen
    s_add_u32 m0, s19, 49152
    s_add_u32 s22, s18, 0
    buffer_load_dwordx4 v10, s[12:15], s22 offen lds
    s_add_u32 m0, s19, 53248
    s_add_u32 s22, s18, 44032
    buffer_load_dwordx4 v10, s[12:15], s22 offen lds
    s_add_u32 m0, s19, 57344
    s_add_u32 s22, s18, 88064
    buffer_load_dwordx4 v10, s[12:15], s22 offen lds
    s_add_u32 m0, s19, 61440
    s_add_u32 s22, s18, 132096
    buffer_load_dwordx4 v10, s[12:15], s22 offen lds
    s_add_u32 m0, s19, 32768
    s_nop 0
    buffer_load_dwordx4 v13, s[8:11], s17 offen lds
    s_add_u32 m0, s19, 36864
    s_nop 0
    buffer_load_dwordx4 v14, s[8:11], s17 offen lds
    s_add_u32 m0, s19, 40960
    s_nop 0
    buffer_load_dwordx4 v15, s[8:11], s17 offen lds
    s_add_u32 m0, s19, 45056
    s_nop 0
    buffer_load_dwordx4 v16, s[8:11], s17 offen lds
    s_add_u32 s17, s17, 128
    s_add_u32 s18, s18, 176128
    s_cmp_eq_u32 s17, 1024
    s_cselect_b32 s17, 0, s17
    s_cselect_b32 s22, 1409024, 0
    s_sub_u32 s18, s18, s22
    v_mov_b32 v236, 0
    buffer_load_dword v236, v236, s[64:67], 0 offen sc1
    s_bfe_u32 s20, s2, 0x10001
    s_lshl_b32 s23, s20, 15
    v_bfe_u32 v4, v1, 2, 1
    v_bfe_u32 v5, v1, 3, 1
    v_bfe_u32 v6, v1, 4, 1
    v_lshl_or_b32 v4, v4, 1, v6
    v_lshl_or_b32 v6, v5, 2, v4
    v_lshl_or_b32 v4, v5, 3, v4
    v_lshrrev_b32 v5, 5, v1
    v_lshl_or_b32 v4, v5, 2, v4
    v_and_b32 v5, 3, v1
    s_lshl_b32 s22, s16, 2
    v_or_b32 v5, s22, v5
    v_lshlrev_b32 v6, 1, v6
    v_xor_b32 v5, v5, v6
    v_lshl_add_u32 v5, v5, 4, s23
    v_lshl_add_u32 v238, v4, 8, v5
    s_lshr_b32 s21, s30, 7
    s_bfe_u32 s22, s2, 0x10002
    s_lshl_b32 s22, s22, 4
    s_add_u32 s21, s21, s22
    s_lshl_b32 s21, s21, 13
    s_add_u32 s21, s21, 15204352
    s_add_u32 s20, s20, s56
    s_and_b32 s20, s20, 7
    s_lshl_b32 s20, s20, 10
    s_add_u32 s20, s20, s21
    v_and_b32 v4, 3, v1
    v_mov_b32 v237, v13
    v_cmp_eq_u32 vcc, 1, v4
    s_nop 1
    v_cndmask_b32 v237, v237, v14, vcc
    v_cmp_eq_u32 vcc, 2, v4
    s_nop 1
    v_cndmask_b32 v237, v237, v15, vcc
    v_cmp_eq_u32 vcc, 3, v4
    s_nop 1
    v_cndmask_b32 v237, v237, v16, vcc
    v_lshrrev_b32 v237, 10, v237
    v_lshlrev_b32 v237, 4, v237
    v_add_u32 v237, 14745600, v237
    v_and_b32 v4, 7, v1
    v_lshlrev_b32 v4, 5, v4
    v_lshl_add_u32 v4, v2, 10, v4
    s_lshl_b32 s22, s16, 8
    v_add_u32 v239, s22, v4
    s_waitcnt vmcnt(11)
    s_barrier
    s_add_u32 m0, s19, 81920
    s_add_u32 s22, s18, 0
    buffer_load_dwordx4 v10, s[12:15], s22 offen lds
    s_add_u32 m0, s19, 86016
    s_add_u32 s22, s18, 44032
    buffer_load_dwordx4 v10, s[12:15], s22 offen lds
    s_add_u32 m0, s19, 90112
    s_add_u32 s22, s18, 88064
    buffer_load_dwordx4 v10, s[12:15], s22 offen lds
    s_add_u32 m0, s19, 94208
    s_add_u32 s22, s18, 132096
    buffer_load_dwordx4 v10, s[12:15], s22 offen lds
    s_add_u32 m0, s19, 65536
    s_nop 0
    buffer_load_dwordx4 v13, s[8:11], s17 offen lds
    s_add_u32 m0, s19, 69632
    s_nop 0
    buffer_load_dwordx4 v14, s[8:11], s17 offen lds
    s_add_u32 m0, s19, 73728
    s_nop 0
    buffer_load_dwordx4 v15, s[8:11], s17 offen lds
    s_add_u32 m0, s19, 77824
    s_nop 0
    buffer_load_dwordx4 v16, s[8:11], s17 offen lds
    s_add_u32 s17, s17, 128
    s_add_u32 s18, s18, 176128
    s_cmp_eq_u32 s17, 1024
    s_cselect_b32 s17, 0, s17
    s_cselect_b32 s22, 1409024, 0
    s_sub_u32 s18, s18, s22
    s_waitcnt vmcnt(17)
    s_mov_b32 s42, 0x3f803f80
    v_mov_b32 v242, 0
    v_mov_b32 v243, 0
    v_mov_b32 v244, 0
    v_mov_b32 v245, 0
    v_dot2c_f32_bf16 v242, s42, v216
    v_dot2c_f32_bf16 v244, v216, v216
    v_dot2c_f32_bf16 v243, s42, v220
    v_dot2c_f32_bf16 v245, v220, v220
    v_dot2c_f32_bf16 v242, s42, v217
    v_dot2c_f32_bf16 v244, v217, v217
    v_dot2c_f32_bf16 v243, s42, v221
    v_dot2c_f32_bf16 v245, v221, v221
    v_dot2c_f32_bf16 v242, s42, v218
    v_dot2c_f32_bf16 v244, v218, v218
    v_dot2c_f32_bf16 v243, s42, v222
    v_dot2c_f32_bf16 v245, v222, v222
    v_dot2c_f32_bf16 v242, s42, v219
    v_dot2c_f32_bf16 v244, v219, v219
    v_dot2c_f32_bf16 v243, s42, v223
    v_dot2c_f32_bf16 v245, v223, v223
    v_mov_b32 v249, s41
    v_mov_b32 v248, s40
    v_cmp_gt_u32 vcc, 32, v1
    v_permlane32_swap_b32 v242, v243
    v_permlane32_swap_b32 v244, v245
    v_cndmask_b32 v249, v249, v248, vcc
    v_add_f32 v242, v242, v243
    v_add_f32 v244, v244, v245
    v_lshlrev_b32 v249, 4, v249
    s_nop 0
    v_permlane16_swap_b32 v242, v244
    s_nop 0
    v_add_f32 v242, v242, v244
    s_nop 1
    v_add_f32_dpp v242, v242, v242 row_ror:8 row_mask:0xf bank_mask:0xf
    s_nop 1
    v_add_f32_dpp v242, v242, v242 row_ror:4 row_mask:0xf bank_mask:0xf
    s_nop 1
    v_add_f32_dpp v242, v242, v242 row_ror:2 row_mask:0xf bank_mask:0xf
    s_nop 1
    v_add_f32_dpp v242, v242, v242 row_ror:1 row_mask:0xf bank_mask:0xf
    v_mov_b32 v243, v242
    s_nop 1
    v_permlane16_swap_b32 v242, v243
    s_nop 0
    v_mul_f32 v242, 0x3b000000, v242
    v_mul_f32 v243, 0x3b000000, v243
    v_fma_f32 v243, -v242, v242, v243
    v_max_f32 v243, 0, v243
    v_mov_b32 v245, v243
    v_cvt_pk_bf16_f32 v245, v245, v245
    v_lshlrev_b32 v245, 16, v245
    v_add_f32 v245, 0x3727c5ac, v245
    v_cvt_pk_bf16_f32 v245, v245, v245
    v_lshlrev_b32 v245, 16, v245
    v_sqrt_f32 v245, v245
    s_nop 0
    v_cvt_pk_bf16_f32 v218, v242, v245
    v_lshlrev_b32 v244, 16, v218
    v_and_b32 v245, 0xffff0000, v218
    v_rcp_f32 v245, v245
    v_sub_f32 v246, v242, v244
    v_mul_f32 v246, v246, v245
    v_cvt_pk_bf16_f32 v246, v246, v246
    v_lshlrev_b32 v246, 16, v246
    v_mul_f32 v243, v243, v245
    v_mul_f32 v243, v243, v245
    v_cvt_pk_bf16_f32 v243, v243, v243
    v_lshlrev_b32 v243, 16, v243
    v_add_f32 v243, 0x3727c5ac, v243
    v_cvt_pk_bf16_f32 v243, v243, v243
    v_lshlrev_b32 v243, 16, v243
    v_sqrt_f32 v243, v243
    s_nop 0
    v_cvt_pk_bf16_f32 v243, v243, v243
    v_lshlrev_b32 v243, 16, v243
    v_rcp_f32 v243, v243
    v_fma_f32 v244, v244, v245, v246
    v_mul_f32 v217, v244, v243
    v_mul_f32 v216, v245, v243
    s_waitcnt vmcnt(8)
    v_readfirstlane_b32 s63, v236
    s_mov_b32 s23, 0x20000
L_tk4:
    s_cmp_lg_u32 s63, 0
    s_cbranch_scc1 L_tk4x
    s_sub_u32 s23, s23, 1
    s_cmp_eq_u32 s23, 0
    s_cbranch_scc1 L_tk4x
    s_sleep 4
    v_mov_b32 v242, 0
    buffer_load_dword v236, v242, s[64:67], 0 offen sc1
    s_waitcnt vmcnt(0)
    v_readfirstlane_b32 s63, v236
    s_branch L_tk4
L_tk4x:
    v_mov_b32 v219, s63
    s_mov_b32 s22, 14745600
    s_mov_b32 exec_lo, 1
    s_mov_b32 exec_hi, 1
    buffer_store_dwordx4 v[216:219], v249, s[24:27], s22 offen sc1
    s_mov_b64 exec, -1
    s_waitcnt vmcnt(9)
    s_barrier
    ds_read_b128 v[192:195], v238 offset:16384
    ds_read_b128 v[196:199], v238 offset:20480
    ds_read_b128 v[200:203], v238 offset:24576
    ds_read_b128 v[204:207], v238 offset:28672
    s_add_u32 m0, s19, 114688
    s_add_u32 s22, s18, 0
    buffer_load_dwordx4 v10, s[12:15], s22 offen lds
    s_add_u32 m0, s19, 118784
    s_add_u32 s22, s18, 44032
    buffer_load_dwordx4 v10, s[12:15], s22 offen lds
    s_add_u32 m0, s19, 122880
    s_add_u32 s22, s18, 88064
    buffer_load_dwordx4 v10, s[12:15], s22 offen lds
    s_add_u32 m0, s19, 126976
    s_add_u32 s22, s18, 132096
    buffer_load_dwordx4 v10, s[12:15], s22 offen lds
    s_add_u32 m0, s19, 98304
    s_nop 0
    buffer_load_dwordx4 v13, s[8:11], s17 offen lds
    s_add_u32 m0, s19, 102400
    s_nop 0
    buffer_load_dwordx4 v14, s[8:11], s17 offen lds
    s_add_u32 m0, s19, 106496
    s_nop 0
    buffer_load_dwordx4 v15, s[8:11], s17 offen lds
    s_add_u32 m0, s19, 110592
    s_nop 0
    buffer_load_dwordx4 v16, s[8:11], s17 offen lds
    s_add_u32 s17, s17, 128
    s_add_u32 s18, s18, 176128
    s_cmp_eq_u32 s17, 1024
    s_cselect_b32 s17, 0, s17
    s_cselect_b32 s22, 1409024, 0
    s_sub_u32 s18, s18, s22
    s_waitcnt lgkmcnt(0)
    v_lshlrev_b32 v208, 16, v192
    v_and_b32 v209, 0xffff0000, v192
    v_lshlrev_b32 v210, 16, v193
    v_and_b32 v211, 0xffff0000, v193
    v_lshlrev_b32 v212, 16, v194
    v_and_b32 v213, 0xffff0000, v194
    v_lshlrev_b32 v214, 16, v195
    v_and_b32 v215, 0xffff0000, v195
    v_lshlrev_b32 v242, 16, v196
    v_and_b32 v196, 0xffff0000, v196
    v_lshlrev_b32 v243, 16, v197
    v_and_b32 v197, 0xffff0000, v197
    v_lshlrev_b32 v244, 16, v198
    v_and_b32 v198, 0xffff0000, v198
    v_lshlrev_b32 v245, 16, v199
    v_and_b32 v199, 0xffff0000, v199
    v_add_f32 v208, v208, v242
    v_add_f32 v209, v209, v196
    v_add_f32 v210, v210, v243
    v_add_f32 v211, v211, v197
    v_add_f32 v212, v212, v244
    v_add_f32 v213, v213, v198
    v_add_f32 v214, v214, v245
    v_add_f32 v215, v215, v199
    v_lshlrev_b32 v242, 16, v200
    v_and_b32 v200, 0xffff0000, v200
    v_lshlrev_b32 v243, 16, v201
    v_and_b32 v201, 0xffff0000, v201
    v_lshlrev_b32 v244, 16, v202
    v_and_b32 v202, 0xffff0000, v202
    v_lshlrev_b32 v245, 16, v203
    v_and_b32 v203, 0xffff0000, v203
    v_add_f32 v208, v208, v242
    v_add_f32 v209, v209, v200
    v_add_f32 v210, v210, v243
    v_add_f32 v211, v211, v201
    v_add_f32 v212, v212, v244
    v_add_f32 v213, v213, v202
    v_add_f32 v214, v214, v245
    v_add_f32 v215, v215, v203
    v_lshlrev_b32 v242, 16, v204
    v_and_b32 v204, 0xffff0000, v204
    v_lshlrev_b32 v243, 16, v205
    v_and_b32 v205, 0xffff0000, v205
    v_lshlrev_b32 v244, 16, v206
    v_and_b32 v206, 0xffff0000, v206
    v_lshlrev_b32 v245, 16, v207
    v_and_b32 v207, 0xffff0000, v207
    v_add_f32 v208, v208, v242
    v_add_f32 v209, v209, v204
    v_add_f32 v210, v210, v243
    v_add_f32 v211, v211, v205
    v_add_f32 v212, v212, v244
    v_add_f32 v213, v213, v206
    v_add_f32 v214, v214, v245
    v_add_f32 v215, v215, v207
    v_and_b32 v4, 3, v1
    v_lshlrev_b32 v4, 6, v4
    v_lshrrev_b32 v5, 5, v1
    v_permlane32_swap_b32 v208, v212
    v_permlane32_swap_b32 v209, v213
    v_permlane32_swap_b32 v210, v214
    v_permlane32_swap_b32 v211, v215
    v_lshl_add_u32 v4, v5, 5, v4
    v_and_b32 v5, 1, v3
    v_add_f32 v208, v208, v212
    v_add_f32 v209, v209, v213
    v_add_f32 v210, v210, v214
    v_add_f32 v211, v211, v215
    v_lshl_add_u32 v4, v5, 4, v4
    s_lshl_b32 s22, s16, 8
    v_permlane16_swap_b32 v208, v210
    v_permlane16_swap_b32 v209, v211
    s_add_u32 s22, s22, s20
    v_add_f32 v212, v208, v210
    v_add_f32 v214, v209, v211
    v_mov_b32 v213, s63
    v_mov_b32 v215, s63
    v_add_f32_dpp v212, v212, v212 row_ror:8 row_mask:0xf bank_mask:0xf
    v_add_f32_dpp v214, v214, v214 row_ror:8 row_mask:0xf bank_mask:0xf
    s_nop 0
    v_add_f32_dpp v212, v212, v212 row_ror:4 row_mask:0xf bank_mask:0xf
    v_add_f32_dpp v214, v214, v214 row_ror:4 row_mask:0xf bank_mask:0xf
    s_nop 0
    s_mov_b32 exec_lo, 0x000f000f
    s_mov_b32 exec_hi, 0x000f000f
    buffer_store_dwordx4 v[212:215], v4, s[24:27], s22 offen sc1
    s_mov_b64 exec, -1
    s_waitcnt vmcnt(8)
    s_barrier
    s_add_u32 m0, s19, 16384
    s_add_u32 s22, s18, 0
    buffer_load_dwordx4 v10, s[12:15], s22 offen lds
    s_add_u32 m0, s19, 20480
    s_add_u32 s22, s18, 44032
    buffer_load_dwordx4 v10, s[12:15], s22 offen lds
    s_add_u32 m0, s19, 24576
    s_add_u32 s22, s18, 88064
    buffer_load_dwordx4 v10, s[12:15], s22 offen lds
    s_add_u32 m0, s19, 28672
    s_add_u32 s22, s18, 132096
    buffer_load_dwordx4 v10, s[12:15], s22 offen lds
    s_add_u32 m0, s19, 0
    s_nop 0
    buffer_load_dwordx4 v13, s[8:11], s17 offen lds
    s_add_u32 m0, s19, 4096
    s_nop 0
    buffer_load_dwordx4 v14, s[8:11], s17 offen lds
    s_add_u32 m0, s19, 8192
    s_nop 0
    buffer_load_dwordx4 v15, s[8:11], s17 offen lds
    s_add_u32 m0, s19, 12288
    s_nop 0
    buffer_load_dwordx4 v16, s[8:11], s17 offen lds
    s_add_u32 s17, s17, 128
    s_add_u32 s18, s18, 176128
    s_cmp_eq_u32 s17, 1024
    s_cselect_b32 s17, 0, s17
    s_cselect_b32 s22, 1409024, 0
    s_sub_u32 s18, s18, s22
    s_waitcnt vmcnt(8)
    s_barrier
    s_add_u32 m0, s19, 49152
    s_add_u32 s22, s18, 0
    buffer_load_dwordx4 v10, s[12:15], s22 offen lds
    s_add_u32 m0, s19, 53248
    s_add_u32 s22, s18, 44032
    buffer_load_dwordx4 v10, s[12:15], s22 offen lds
    s_add_u32 m0, s19, 57344
    s_add_u32 s22, s18, 88064
    buffer_load_dwordx4 v10, s[12:15], s22 offen lds
    s_add_u32 m0, s19, 61440
    s_add_u32 s22, s18, 132096
    buffer_load_dwordx4 v10, s[12:15], s22 offen lds
    s_add_u32 m0, s19, 32768
    s_nop 0
    buffer_load_dwordx4 v13, s[8:11], s17 offen lds
    s_add_u32 m0, s19, 36864
    s_nop 0
    buffer_load_dwordx4 v14, s[8:11], s17 offen lds
    s_add_u32 m0, s19, 40960
    s_nop 0
    buffer_load_dwordx4 v15, s[8:11], s17 offen lds
    s_add_u32 m0, s19, 45056
    s_nop 0
    buffer_load_dwordx4 v16, s[8:11], s17 offen lds
    s_add_u32 s17, s17, 128
    s_add_u32 s18, s18, 176128
    s_cmp_eq_u32 s17, 1024
    s_cselect_b32 s17, 0, s17
    s_cselect_b32 s22, 1409024, 0
    s_sub_u32 s18, s18, s22
    s_waitcnt vmcnt(8)
    s_barrier
    s_add_u32 m0, s19, 81920
    s_add_u32 s22, s18, 0
    buffer_load_dwordx4 v10, s[12:15], s22 offen lds
    s_add_u32 m0, s19, 86016
    s_add_u32 s22, s18, 44032
    buffer_load_dwordx4 v10, s[12:15], s22 offen lds
    s_add_u32 m0, s19, 90112
    s_add_u32 s22, s18, 88064
    buffer_load_dwordx4 v10, s[12:15], s22 offen lds
    s_add_u32 m0, s19, 94208
    s_add_u32 s22, s18, 132096
    buffer_load_dwordx4 v10, s[12:15], s22 offen lds
    s_add_u32 m0, s19, 65536
    s_nop 0
    buffer_load_dwordx4 v13, s[8:11], s17 offen lds
    s_add_u32 m0, s19, 69632
    s_nop 0
    buffer_load_dwordx4 v14, s[8:11], s17 offen lds
    s_add_u32 m0, s19, 73728
    s_nop 0
    buffer_load_dwordx4 v15, s[8:11], s17 offen lds
    s_add_u32 m0, s19, 77824
    s_nop 0
    buffer_load_dwordx4 v16, s[8:11], s17 offen lds
    s_add_u32 s17, s17, 128
    s_add_u32 s18, s18, 176128
    s_cmp_eq_u32 s17, 1024
    s_cselect_b32 s17, 0, s17
    s_cselect_b32 s22, 1409024, 0
    s_sub_u32 s18, s18, s22
    s_waitcnt vmcnt(8)
    s_barrier
    s_add_u32 m0, s19, 114688
    s_add_u32 s22, s18, 0
    buffer_load_dwordx4 v10, s[12:15], s22 offen lds
    s_add_u32 m0, s19, 118784
    s_add_u32 s22, s18, 44032
    buffer_load_dwordx4 v10, s[12:15], s22 offen lds
    s_add_u32 m0, s19, 122880
    s_add_u32 s22, s18, 88064
    buffer_load_dwordx4 v10, s[12:15], s22 offen lds
    s_add_u32 m0, s19, 126976
    s_add_u32 s22, s18, 132096
    buffer_load_dwordx4 v10, s[12:15], s22 offen lds
    s_add_u32 m0, s19, 98304
    s_nop 0
    buffer_load_dwordx4 v13, s[8:11], s17 offen lds
    s_add_u32 m0, s19, 102400
    s_nop 0
    buffer_load_dwordx4 v14, s[8:11], s17 offen lds
    s_add_u32 m0, s19, 106496
    s_nop 0
    buffer_load_dwordx4 v15, s[8:11], s17 offen lds
    s_add_u32 m0, s19, 110592
    s_nop 0
    buffer_load_dwordx4 v16, s[8:11], s17 offen lds
    s_waitcnt vmcnt(8)
    s_barrier
    buffer_load_dwordx4 v[224:227], v237, s[24:27], 0 offen sc1
    buffer_load_dwordx4 v[228:231], v239, s[24:27], s21 offen sc1
    buffer_load_dwordx4 v[232:235], v239, s[24:27], s21 offen offset:16 sc1
    s_waitcnt vmcnt(3)
    s_barrier
    v_and_b32 v4, 1, v1
    v_bfe_u32 v5, v1, 1, 1
    v_lshlrev_b32 v4, 7, v4
    v_lshl_add_u32 v4, v5, 9, v4
    v_lshl_add_u32 v4, v2, 2, v4
    s_lshl_b32 s22, s16, 5
    s_add_u32 s22, s22, 131072
    v_add_u32 v4, s22, v4
    v_mov_b32 v5, 162572
    v_and_b32 v6, 7, v1
    v_lshlrev_b32 v6, 4, v6
    v_and_b32 v7, 1, v3
    v_lshl_add_u32 v6, v7, 3, v6
    v_lshrrev_b32 v7, 5, v1
    v_lshl_add_u32 v6, v7, 2, v6
    s_lshl_b32 s22, s16, 7
    s_add_u32 s22, s22, 132096
    v_add_u32 v6, s22, v6
    s_mov_b32 s23, 0x10000
    s_waitcnt vmcnt(0)
L_ga5:
    v_xor_b32 v7, s63, v227
    v_xor_b32 v8, s63, v229
    v_or_b32 v7, v7, v8
    v_xor_b32 v8, s63, v231
    v_or_b32 v7, v7, v8
    v_xor_b32 v8, s63, v233
    v_or_b32 v7, v7, v8
    v_xor_b32 v8, s63, v235
    v_or_b32 v7, v7, v8
    v_cmp_ne_u32 vcc, 0, v7
    s_cbranch_vccz L_ga5x
    s_sub_u32 s23, s23, 1
    s_cmp_eq_u32 s23, 0
    s_cbranch_scc1 L_ga5x
    s_sleep 4
    buffer_load_dwordx4 v[224:227], v237, s[24:27], 0 offen sc1
    buffer_load_dwordx4 v[228:231], v239, s[24:27], s21 offen sc1
    buffer_load_dwordx4 v[232:235], v239, s[24:27], s21 offen offset:16 sc1
    s_waitcnt vmcnt(0)
    s_branch L_ga5
L_ga5x:
    v_permlane32_swap_b32 v228, v230
    v_permlane32_swap_b32 v232, v234
    v_add_f32 v228, v228, v230
    v_add_f32 v232, v232, v234
    s_nop 1
    v_permlane16_swap_b32 v228, v232
    ds_write_b32 v4, v224
    v_add_f32 v228, v228, v232
    ds_write_b32 v4, v225 offset:256
    ds_write_b32 v5, v227
    v_add_f32_dpp v228, v228, v228 row_ror:8 row_mask:0xf bank_mask:0xf
    ds_write_b32 v6, v228
    s_waitcnt lgkmcnt(0)
    s_barrier
    s_branch L_p2_z
L_k1b_cons:
    v_and_b32 v1, 63, v0
    buffer_load_dwordx2 v[184:185], v12, s[36:39], s33 offen offset:0
    buffer_load_dwordx2 v[186:187], v12, s[36:39], s33 offen offset:32
    buffer_load_dwordx2 v[188:189], v12, s[36:39], s33 offen offset:64
    buffer_load_dwordx2 v[190:191], v12, s[36:39], s33 offen offset:96
    s_lshr_b32 s22, s2, 3
    s_cmp_lg_u32 s16, 0
    s_cbranch_scc1 L_pf6
    s_lshr_b32 s23, s22, 2
    s_lshl_b32 s23, s23, 18
    s_and_b32 s22, s22, 3
    s_lshl_b32 s22, s22, 13
    s_add_u32 s22, s22, s23
    s_and_b32 s23, s2, 7
    s_lshl_b32 s23, s23, 15
    s_add_u32 s22, s22, s23
    s_mov_b32 s88, s6
    s_mov_b32 s89, s7
    s_mov_b32 s90, 1409024
    s_mov_b32 s91, 0x20000
    v_lshlrev_b32 v13, 7, v1
    buffer_load_dword v13, v13, s[88:91], s22 offen
L_pf6:
    s_and_b32 s22, s2, 6
    s_sub_u32 s23, 12, s22
    s_cmp_lt_u32 s2, 128
    s_cselect_b32 s22, s22, s23
    s_lshr_b32 s23, s2, 6
    s_add_u32 s22, s22, s23
    s_lshl_b32 s22, s22, 6
    s_and_b32 s23, s2, 1
    s_add_u32 s22, s22, s23
    v_and_b32 v8, 15, v1
    v_lshl_add_u32 v8, v8, 1, s22
    v_lshlrev_b32 v42, 12, v8
    v_add_u32 v43, 131072, v42
    v_lshrrev_b32 v8, 4, v1
    s_lshr_b32 s22, s16, 1
    s_lshl_b32 s22, s22, 8
    v_lshl_add_u32 v8, v8, 3, s22
    v_mul_lo_u32 v40, v8, v42
    v_mul_lo_u32 v41, v8, v43
    s_and_b32 s22, s16, 1
    s_lshl_b32 s22, s22, 21
    v_add_u32 v40, s22, v40
    v_add_u32 v41, s22, v41
    v_mov_b32 v44, 1.0
    v_mul_u32_u24 v45, 24, v42
    v_mul_u32_u24 v46, 24, v43
    s_mov_b32 s59, 0x7ff000
    v_and_or_b32 v32, v40, s59, v44
    v_add_u32 v40, v40, v42
    v_and_or_b32 v33, v40, s59, v44
    v_add_u32 v40, v40, v42
    v_and_or_b32 v34, v40, s59, v44
    v_add_u32 v40, v40, v42
    v_and_or_b32 v35, v40, s59, v44
    v_add_u32 v40, v40, v42
    v_and_or_b32 v36, v40, s59, v44
    v_add_u32 v40, v40, v42
    v_and_or_b32 v37, v40, s59, v44
    v_add_u32 v40, v40, v42
    v_and_or_b32 v38, v40, s59, v44
    v_add_u32 v40, v40, v42
    v_and_or_b32 v39, v40, s59, v44
    v_add_u32 v40, v40, v42
    v_cos_f32 v32, v32
    v_cos_f32 v33, v33
    v_cos_f32 v34, v34
    v_cos_f32 v35, v35
    v_cos_f32 v36, v36
    v_cos_f32 v37, v37
    v_cos_f32 v38, v38
    v_cos_f32 v39, v39
    v_add_u32 v40, v40, v45
    v_cvt_pk_bf16_f32 v192, v32, v33
    v_cvt_pk_bf16_f32 v193, v34, v35
    v_cvt_pk_bf16_f32 v194, v36, v37
    v_cvt_pk_bf16_f32 v195, v38, v39
    v_and_or_b32 v32, v41, s59, v44
    v_add_u32 v41, v41, v43
    v_and_or_b32 v33, v41, s59, v44
    v_add_u32 v41, v41, v43
    v_and_or_b32 v34, v41, s59, v44
    v_add_u32 v41, v41, v43
    v_and_or_b32 v35, v41, s59, v44
    v_add_u32 v41, v41, v43
    v_and_or_b32 v36, v41, s59, v44
    v_add_u32 v41, v41, v43
    v_and_or_b32 v37, v41, s59, v44
    v_add_u32 v41, v41, v43
    v_and_or_b32 v38, v41, s59, v44
    v_add_u32 v41, v41, v43
    v_and_or_b32 v39, v41, s59, v44
    v_add_u32 v41, v41, v43
    v_cos_f32 v32, v32
    v_cos_f32 v33, v33
    v_cos_f32 v34, v34
    v_cos_f32 v35, v35
    v_cos_f32 v36, v36
    v_cos_f32 v37, v37
    v_cos_f32 v38, v38
    v_cos_f32 v39, v39
    v_add_u32 v41, v41, v46
    v_cvt_pk_bf16_f32 v196, v32, v33
    v_cvt_pk_bf16_f32 v197, v34, v35
    v_cvt_pk_bf16_f32 v198, v36, v37
    v_cvt_pk_bf16_f32 v199, v38, v39
    v_and_or_b32 v32, v40, s59, v44
    v_add_u32 v40, v40, v42
    v_and_or_b32 v33, v40, s59, v44
    v_add_u32 v40, v40, v42
    v_and_or_b32 v34, v40, s59, v44
    v_add_u32 v40, v40, v42
    v_and_or_b32 v35, v40, s59, v44
    v_add_u32 v40, v40, v42
    v_and_or_b32 v36, v40, s59, v44
    v_add_u32 v40, v40, v42
    v_and_or_b32 v37, v40, s59, v44
    v_add_u32 v40, v40, v42
    v_and_or_b32 v38, v40, s59, v44
    v_add_u32 v40, v40, v42
    v_and_or_b32 v39, v40, s59, v44
    v_add_u32 v40, v40, v42
    v_cos_f32 v32, v32
    v_cos_f32 v33, v33
    v_cos_f32 v34, v34
    v_cos_f32 v35, v35
    v_cos_f32 v36, v36
    v_cos_f32 v37, v37
    v_cos_f32 v38, v38
    v_cos_f32 v39, v39
    v_add_u32 v40, v40, v45
    v_cvt_pk_bf16_f32 v200, v32, v33
    v_cvt_pk_bf16_f32 v201, v34, v35
    v_cvt_pk_bf16_f32 v202, v36, v37
    v_cvt_pk_bf16_f32 v203, v38, v39
    v_and_or_b32 v32, v41, s59, v44
    v_add_u32 v41, v41, v43
    v_and_or_b32 v33, v41, s59, v44
    v_add_u32 v41, v41, v43
    v_and_or_b32 v34, v41, s59, v44
    v_add_u32 v41, v41, v43
    v_and_or_b32 v35, v41, s59, v44
    v_add_u32 v41, v41, v43
    v_and_or_b32 v36, v41, s59, v44
    v_add_u32 v41, v41, v43
    v_and_or_b32 v37, v41, s59, v44
    v_add_u32 v41, v41, v43
    v_and_or_b32 v38, v41, s59, v44
    v_add_u32 v41, v41, v43
    v_and_or_b32 v39, v41, s59, v44
    v_add_u32 v41, v41, v43
    v_cos_f32 v32, v32
    v_cos_f32 v33, v33
    v_cos_f32 v34, v34
    v_cos_f32 v35, v35
    v_cos_f32 v36, v36
    v_cos_f32 v37, v37
    v_cos_f32 v38, v38
    v_cos_f32 v39, v39
    v_add_u32 v41, v41, v46
    v_cvt_pk_bf16_f32 v204, v32, v33
    v_cvt_pk_bf16_f32 v205, v34, v35
    v_cvt_pk_bf16_f32 v206, v36, v37
    v_cvt_pk_bf16_f32 v207, v38, v39
    v_and_or_b32 v32, v40, s59, v44
    v_add_u32 v40, v40, v42
    v_and_or_b32 v33, v40, s59, v44
    v_add_u32 v40, v40, v42
    v_and_or_b32 v34, v40, s59, v44
    v_add_u32 v40, v40, v42
    v_and_or_b32 v35, v40, s59, v44
    v_add_u32 v40, v40, v42
    v_and_or_b32 v36, v40, s59, v44
    v_add_u32 v40, v40, v42
    v_and_or_b32 v37, v40, s59, v44
    v_add_u32 v40, v40, v42
    v_and_or_b32 v38, v40, s59, v44
    v_add_u32 v40, v40, v42
    v_and_or_b32 v39, v40, s59, v44
    v_add_u32 v40, v40, v42
    v_cos_f32 v32, v32
    v_cos_f32 v33, v33
    v_cos_f32 v34, v34
    v_cos_f32 v35, v35
    v_cos_f32 v36, v36
    v_cos_f32 v37, v37
    v_cos_f32 v38, v38
    v_cos_f32 v39, v39
    v_add_u32 v40, v40, v45
    v_cvt_pk_bf16_f32 v208, v32, v33
    v_cvt_pk_bf16_f32 v209, v34, v35
    v_cvt_pk_bf16_f32 v210, v36, v37
    v_cvt_pk_bf16_f32 v211, v38, v39
    v_and_or_b32 v32, v41, s59, v44
    v_add_u32 v41, v41, v43
    v_and_or_b32 v33, v41, s59, v44
    v_add_u32 v41, v41, v43
    v_and_or_b32 v34, v41, s59, v44
    v_add_u32 v41, v41, v43
    v_and_or_b32 v35, v41, s59, v44
    v_add_u32 v41, v41, v43
    v_and_or_b32 v36, v41, s59, v44
    v_add_u32 v41, v41, v43
    v_and_or_b32 v37, v41, s59, v44
    v_add_u32 v41, v41, v43
    v_and_or_b32 v38, v41, s59, v44
    v_add_u32 v41, v41, v43
    v_and_or_b32 v39, v41, s59, v44
    v_add_u32 v41, v41, v43
    v_cos_f32 v32, v32
    v_cos_f32 v33, v33
    v_cos_f32 v34, v34
    v_cos_f32 v35, v35
    v_cos_f32 v36, v36
    v_cos_f32 v37, v37
    v_cos_f32 v38, v38
    v_cos_f32 v39, v39
    v_add_u32 v41, v41, v46
    v_cvt_pk_bf16_f32 v212, v32, v33
    v_cvt_pk_bf16_f32 v213, v34, v35
    v_cvt_pk_bf16_f32 v214, v36, v37
    v_cvt_pk_bf16_f32 v215, v38, v39
    v_and_or_b32 v32, v40, s59, v44
    v_add_u32 v40, v40, v42
    v_and_or_b32 v33, v40, s59, v44
    v_add_u32 v40, v40, v42
    v_and_or_b32 v34, v40, s59, v44
    v_add_u32 v40, v40, v42
    v_and_or_b32 v35, v40, s59, v44
    v_add_u32 v40, v40, v42
    v_and_or_b32 v36, v40, s59, v44
    v_add_u32 v40, v40, v42
    v_and_or_b32 v37, v40, s59, v44
    v_add_u32 v40, v40, v42
    v_and_or_b32 v38, v40, s59, v44
    v_add_u32 v40, v40, v42
    v_and_or_b32 v39, v40, s59, v44
    v_add_u32 v40, v40, v42
    v_cos_f32 v32, v32
    v_cos_f32 v33, v33
    v_cos_f32 v34, v34
    v_cos_f32 v35, v35
    v_cos_f32 v36, v36
    v_cos_f32 v37, v37
    v_cos_f32 v38, v38
    v_cos_f32 v39, v39
    v_add_u32 v40, v40, v45
    v_cvt_pk_bf16_f32 v216, v32, v33
    v_cvt_pk_bf16_f32 v217, v34, v35
    v_cvt_pk_bf16_f32 v218, v36, v37
    v_cvt_pk_bf16_f32 v219, v38, v39
    v_and_or_b32 v32, v41, s59, v44
    v_add_u32 v41, v41, v43
    v_and_or_b32 v33, v41, s59, v44
    v_add_u32 v41, v41, v43
    v_and_or_b32 v34, v41, s59, v44
    v_add_u32 v41, v41, v43
    v_and_or_b32 v35, v41, s59, v44
    v_add_u32 v41, v41, v43
    v_and_or_b32 v36, v41, s59, v44
    v_add_u32 v41, v41, v43
    v_and_or_b32 v37, v41, s59, v44
    v_add_u32 v41, v41, v43
    v_and_or_b32 v38, v41, s59, v44
    v_add_u32 v41, v41, v43
    v_and_or_b32 v39, v41, s59, v44
    v_add_u32 v41, v41, v43
    v_cos_f32 v32, v32
    v_cos_f32 v33, v33
    v_cos_f32 v34, v34
    v_cos_f32 v35, v35
    v_cos_f32 v36, v36
    v_cos_f32 v37, v37
    v_cos_f32 v38, v38
    v_cos_f32 v39, v39
    v_add_u32 v41, v41, v46
    v_cvt_pk_bf16_f32 v220, v32, v33
    v_cvt_pk_bf16_f32 v221, v34, v35
    v_cvt_pk_bf16_f32 v222, v36, v37
    v_cvt_pk_bf16_f32 v223, v38, v39
    v_and_or_b32 v32, v40, s59, v44
    v_add_u32 v40, v40, v42
    v_and_or_b32 v33, v40, s59, v44
    v_add_u32 v40, v40, v42
    v_and_or_b32 v34, v40, s59, v44
    v_add_u32 v40, v40, v42
    v_and_or_b32 v35, v40, s59, v44
    v_add_u32 v40, v40, v42
    v_and_or_b32 v36, v40, s59, v44
    v_add_u32 v40, v40, v42
    v_and_or_b32 v37, v40, s59, v44
    v_add_u32 v40, v40, v42
    v_and_or_b32 v38, v40, s59, v44
    v_add_u32 v40, v40, v42
    v_and_or_b32 v39, v40, s59, v44
    v_add_u32 v40, v40, v42
    v_cos_f32 v32, v32
    v_cos_f32 v33, v33
    v_cos_f32 v34, v34
    v_cos_f32 v35, v35
    v_cos_f32 v36, v36
    v_cos_f32 v37, v37
    v_cos_f32 v38, v38
    v_cos_f32 v39, v39
    v_add_u32 v40, v40, v45
    v_cvt_pk_bf16_f32 v224, v32, v33
    v_cvt_pk_bf16_f32 v225, v34, v35
    v_cvt_pk_bf16_f32 v226, v36, v37
    v_cvt_pk_bf16_f32 v227, v38, v39
    v_and_or_b32 v32, v41, s59, v44
    v_add_u32 v41, v41, v43
    v_and_or_b32 v33, v41, s59, v44
    v_add_u32 v41, v41, v43
    v_and_or_b32 v34, v41, s59, v44
    v_add_u32 v41, v41, v43
    v_and_or_b32 v35, v41, s59, v44
    v_add_u32 v41, v41, v43
    v_and_or_b32 v36, v41, s59, v44
    v_add_u32 v41, v41, v43
    v_and_or_b32 v37, v41, s59, v44
    v_add_u32 v41, v41, v43
    v_and_or_b32 v38, v41, s59, v44
    v_add_u32 v41, v41, v43
    v_and_or_b32 v39, v41, s59, v44
    v_add_u32 v41, v41, v43
    v_cos_f32 v32, v32
    v_cos_f32 v33, v33
    v_cos_f32 v34, v34
    v_cos_f32 v35, v35
    v_cos_f32 v36, v36
    v_cos_f32 v37, v37
    v_cos_f32 v38, v38
    v_cos_f32 v39, v39
    v_add_u32 v41, v41, v46
    v_cvt_pk_bf16_f32 v228, v32, v33
    v_cvt_pk_bf16_f32 v229, v34, v35
    v_cvt_pk_bf16_f32 v230, v36, v37
    v_cvt_pk_bf16_f32 v231, v38, v39
    v_and_or_b32 v32, v40, s59, v44
    v_add_u32 v40, v40, v42
    v_and_or_b32 v33, v40, s59, v44
    v_add_u32 v40, v40, v42
    v_and_or_b32 v34, v40, s59, v44
    v_add_u32 v40, v40, v42
    v_and_or_b32 v35, v40, s59, v44
    v_add_u32 v40, v40, v42
    v_and_or_b32 v36, v40, s59, v44
    v_add_u32 v40, v40, v42
    v_and_or_b32 v37, v40, s59, v44
    v_add_u32 v40, v40, v42
    v_and_or_b32 v38, v40, s59, v44
    v_add_u32 v40, v40, v42
    v_and_or_b32 v39, v40, s59, v44
    v_add_u32 v40, v40, v42
    v_cos_f32 v32, v32
    v_cos_f32 v33, v33
    v_cos_f32 v34, v34
    v_cos_f32 v35, v35
    v_cos_f32 v36, v36
    v_cos_f32 v37, v37
    v_cos_f32 v38, v38
    v_cos_f32 v39, v39
    v_add_u32 v40, v40, v45
    v_cvt_pk_bf16_f32 v232, v32, v33
    v_cvt_pk_bf16_f32 v233, v34, v35
    v_cvt_pk_bf16_f32 v234, v36, v37
    v_cvt_pk_bf16_f32 v235, v38, v39
    v_and_or_b32 v32, v41, s59, v44
    v_add_u32 v41, v41, v43
    v_and_or_b32 v33, v41, s59, v44
    v_add_u32 v41, v41, v43
    v_and_or_b32 v34, v41, s59, v44
    v_add_u32 v41, v41, v43
    v_and_or_b32 v35, v41, s59, v44
    v_add_u32 v41, v41, v43
    v_and_or_b32 v36, v41, s59, v44
    v_add_u32 v41, v41, v43
    v_and_or_b32 v37, v41, s59, v44
    v_add_u32 v41, v41, v43
    v_and_or_b32 v38, v41, s59, v44
    v_add_u32 v41, v41, v43
    v_and_or_b32 v39, v41, s59, v44
    v_add_u32 v41, v41, v43
    v_cos_f32 v32, v32
    v_cos_f32 v33, v33
    v_cos_f32 v34, v34
    v_cos_f32 v35, v35
    v_cos_f32 v36, v36
    v_cos_f32 v37, v37
    v_cos_f32 v38, v38
    v_cos_f32 v39, v39
    v_add_u32 v41, v41, v46
    v_cvt_pk_bf16_f32 v236, v32, v33
    v_cvt_pk_bf16_f32 v237, v34, v35
    v_cvt_pk_bf16_f32 v238, v36, v37
    v_cvt_pk_bf16_f32 v239, v38, v39
    v_and_or_b32 v32, v40, s59, v44
    v_add_u32 v40, v40, v42
    v_and_or_b32 v33, v40, s59, v44
    v_add_u32 v40, v40, v42
    v_and_or_b32 v34, v40, s59, v44
    v_add_u32 v40, v40, v42
    v_and_or_b32 v35, v40, s59, v44
    v_add_u32 v40, v40, v42
    v_and_or_b32 v36, v40, s59, v44
    v_add_u32 v40, v40, v42
    v_and_or_b32 v37, v40, s59, v44
    v_add_u32 v40, v40, v42
    v_and_or_b32 v38, v40, s59, v44
    v_add_u32 v40, v40, v42
    v_and_or_b32 v39, v40, s59, v44
    v_add_u32 v40, v40, v42
    v_cos_f32 v32, v32
    v_cos_f32 v33, v33
    v_cos_f32 v34, v34
    v_cos_f32 v35, v35
    v_cos_f32 v36, v36
    v_cos_f32 v37, v37
    v_cos_f32 v38, v38
    v_cos_f32 v39, v39
    v_add_u32 v40, v40, v45
    v_cvt_pk_bf16_f32 v240, v32, v33
    v_cvt_pk_bf16_f32 v241, v34, v35
    v_cvt_pk_bf16_f32 v242, v36, v37
    v_cvt_pk_bf16_f32 v243, v38, v39
    v_and_or_b32 v32, v41, s59, v44
    v_add_u32 v41, v41, v43
    v_and_or_b32 v33, v41, s59, v44
    v_add_u32 v41, v41, v43
    v_and_or_b32 v34, v41, s59, v44
    v_add_u32 v41, v41, v43
    v_and_or_b32 v35, v41, s59, v44
    v_add_u32 v41, v41, v43
    v_and_or_b32 v36, v41, s59, v44
    v_add_u32 v41, v41, v43
    v_and_or_b32 v37, v41, s59, v44
    v_add_u32 v41, v41, v43
    v_and_or_b32 v38, v41, s59, v44
    v_add_u32 v41, v41, v43
    v_and_or_b32 v39, v41, s59, v44
    v_add_u32 v41, v41, v43
    v_cos_f32 v32, v32
    v_cos_f32 v33, v33
    v_cos_f32 v34, v34
    v_cos_f32 v35, v35
    v_cos_f32 v36, v36
    v_cos_f32 v37, v37
    v_cos_f32 v38, v38
    v_cos_f32 v39, v39
    v_add_u32 v41, v41, v46
    v_cvt_pk_bf16_f32 v244, v32, v33
    v_cvt_pk_bf16_f32 v245, v34, v35
    v_cvt_pk_bf16_f32 v246, v36, v37
    v_cvt_pk_bf16_f32 v247, v38, v39
    v_and_or_b32 v32, v40, s59, v44
    v_add_u32 v40, v40, v42
    v_and_or_b32 v33, v40, s59, v44
    v_add_u32 v40, v40, v42
    v_and_or_b32 v34, v40, s59, v44
    v_add_u32 v40, v40, v42
    v_and_or_b32 v35, v40, s59, v44
    v_add_u32 v40, v40, v42
    v_and_or_b32 v36, v40, s59, v44
    v_add_u32 v40, v40, v42
    v_and_or_b32 v37, v40, s59, v44
    v_add_u32 v40, v40, v42
    v_and_or_b32 v38, v40, s59, v44
    v_add_u32 v40, v40, v42
    v_and_or_b32 v39, v40, s59, v44
    v_add_u32 v40, v40, v42
    v_cos_f32 v32, v32
    v_cos_f32 v33, v33
    v_cos_f32 v34, v34
    v_cos_f32 v35, v35
    v_cos_f32 v36, v36
    v_cos_f32 v37, v37
    v_cos_f32 v38, v38
    v_cos_f32 v39, v39
    s_nop 0
    v_cvt_pk_bf16_f32 v248, v32, v33
    v_cvt_pk_bf16_f32 v249, v34, v35
    v_cvt_pk_bf16_f32 v250, v36, v37
    v_cvt_pk_bf16_f32 v251, v38, v39
    v_and_or_b32 v32, v41, s59, v44
    v_add_u32 v41, v41, v43
    v_and_or_b32 v33, v41, s59, v44
    v_add_u32 v41, v41, v43
    v_and_or_b32 v34, v41, s59, v44
    v_add_u32 v41, v41, v43
    v_and_or_b32 v35, v41, s59, v44
    v_add_u32 v41, v41, v43
    v_and_or_b32 v36, v41, s59, v44
    v_add_u32 v41, v41, v43
    v_and_or_b32 v37, v41, s59, v44
    v_add_u32 v41, v41, v43
    v_and_or_b32 v38, v41, s59, v44
    v_add_u32 v41, v41, v43
    v_and_or_b32 v39, v41, s59, v44
    v_add_u32 v41, v41, v43
    v_cos_f32 v32, v32
    v_cos_f32 v33, v33
    v_cos_f32 v34, v34
    v_cos_f32 v35, v35
    v_cos_f32 v36, v36
    v_cos_f32 v37, v37
    v_cos_f32 v38, v38
    v_cos_f32 v39, v39
    s_nop 0
    v_cvt_pk_bf16_f32 v252, v32, v33
    v_cvt_pk_bf16_f32 v253, v34, v35
    v_cvt_pk_bf16_f32 v254, v36, v37
    v_cvt_pk_bf16_f32 v255, v38, v39
    v_and_b32 v2, 15, v1
    v_lshrrev_b32 v3, 1, v2
    v_lshrrev_b32 v4, 4, v1
    v_xor_b32 v3, v3, v4
    v_lshlrev_b32 v3, 4, v3
    v_lshlrev_b32 v2, 7, v2
    v_add_u32 v2, v2, v3
    s_lshr_b32 s34, s16, 1
    s_and_b32 s35, s16, 1
    s_lshl_b32 s22, s34, 13
    v_add_u32 v16, s22, v2
    v_xor_b32 v17, 64, v16
    v_bfe_u32 v5, v1, 2, 2
    v_lshl_add_u32 v6, v4, 3, v5
    v_lshlrev_b32 v6, 8, v6
    v_and_b32 v7, 3, v1
    v_lshl_add_u32 v6, v7, 3, v6
    v_add_u32 v6, 16384, v6
    v_and_b32 v7, 1, v4
    v_lshl_or_b32 v5, v7, 2, v5
    s_lshl_b32 s23, s35, 2
    s_add_u32 s22, s23, 0
    v_xor_b32 v7, s22, v5
    v_lshl_add_u32 v20, v7, 5, v6
    s_add_u32 s22, s23, 1
    v_xor_b32 v7, s22, v5
    v_lshl_add_u32 v21, v7, 5, v6
    s_add_u32 s22, s23, 2
    v_xor_b32 v7, s22, v5
    v_lshl_add_u32 v22, v7, 5, v6
    s_add_u32 s22, s23, 3
    v_xor_b32 v7, s22, v5
    v_lshl_add_u32 v23, v7, 5, v6
    v_add_u32 v18, 65536, v16
    v_add_u32 v19, 65536, v17
    v_add_u32 v24, 65536, v20
    v_add_u32 v25, 65536, v21
    v_add_u32 v26, 65536, v22
    v_add_u32 v27, 65536, v23
    v_mov_b32 v92, 0
    v_mov_b32 v93, 0
    v_mov_b32 v94, 0
    v_mov_b32 v95, 0
    v_mov_b32 v96, 0
    v_mov_b32 v97, 0
    v_mov_b32 v98, 0
    v_mov_b32 v99, 0
    v_mov_b32 v100, 0
    v_mov_b32 v101, 0
    v_mov_b32 v102, 0
    v_mov_b32 v103, 0
    v_mov_b32 v104, 0
    v_mov_b32 v105, 0
    v_mov_b32 v106, 0
    v_mov_b32 v107, 0
    v_mov_b32 v108, 0
    v_mov_b32 v109, 0
    v_mov_b32 v110, 0
    v_mov_b32 v111, 0
    v_mov_b32 v112, 0
    v_mov_b32 v113, 0
    v_mov_b32 v114, 0
    v_mov_b32 v115, 0
    v_mov_b32 v116, 0
    v_mov_b32 v117, 0
    v_mov_b32 v118, 0
    v_mov_b32 v119, 0
    v_mov_b32 v120, 0
    v_mov_b32 v121, 0
    v_mov_b32 v122, 0
    v_mov_b32 v123, 0
    v_mov_b32 v124, 0
    v_mov_b32 v125, 0
    v_mov_b32 v126, 0
    v_mov_b32 v127, 0
    v_mov_b32 v128, 0
    v_mov_b32 v129, 0
    v_mov_b32 v130, 0
    v_mov_b32 v131, 0
    v_mov_b32 v132, 0
    v_mov_b32 v133, 0
    v_mov_b32 v134, 0
    v_mov_b32 v135, 0
    v_mov_b32 v136, 0
    v_mov_b32 v137, 0
    v_mov_b32 v138, 0
    v_mov_b32 v139, 0
    v_mov_b32 v140, 0
    v_mov_b32 v141, 0
    v_mov_b32 v142, 0
    v_mov_b32 v143, 0
    v_mov_b32 v144, 0
    v_mov_b32 v145, 0
    v_mov_b32 v146, 0
    v_mov_b32 v147, 0
    v_mov_b32 v148, 0
    v_mov_b32 v149, 0
    v_mov_b32 v150, 0
    v_mov_b32 v151, 0
    v_mov_b32 v152, 0
    v_mov_b32 v153, 0
    v_mov_b32 v154, 0
    v_mov_b32 v155, 0
    v_and_b32 v2, 15, v1
    v_lshrrev_b32 v3, 4, v1
    v_lshlrev_b32 v4, 2, v2
    s_lshl_b32 s22, s35, 8
    s_add_u32 s22, s22, 132096
    s_lshl_b32 s23, s34, 9
    s_add_u32 s23, s23, 131072
    v_lshl_add_u32 v5, v3, 4, s22
    v_add_u32 v6, s23, v4
    v_mov_b32 v7, 162572
    s_mov_b32 s21, 0
    s_waitcnt lgkmcnt(0)
    s_barrier
    ds_read_b64_tr_b16 v[44:45], v20 offset:0
    ds_read_b64_tr_b16 v[46:47], v20 offset:1024
    ds_read_b64_tr_b16 v[48:49], v21 offset:0
    ds_read_b64_tr_b16 v[50:51], v21 offset:1024
    ds_read_b64_tr_b16 v[52:53], v22 offset:0
    ds_read_b64_tr_b16 v[54:55], v22 offset:1024
    ds_read_b64_tr_b16 v[56:57], v23 offset:0
    ds_read_b64_tr_b16 v[58:59], v23 offset:1024
    ds_read_b128 v[28:31], v16 offset:0
    ds_read_b128 v[32:35], v16 offset:2048
    ds_read_b128 v[36:39], v16 offset:4096
    ds_read_b128 v[40:43], v16 offset:6144
L_k1b_loop:
    s_waitcnt lgkmcnt(3)
    v_mfma_f32_16x16x32_bf16 v[96:99], v[48:51], v[28:31], v[96:99]
    ds_read_b64_tr_b16 v[76:77], v20 offset:8192
    v_mfma_f32_16x16x32_bf16 v[100:103], v[52:55], v[28:31], v[100:103]
    ds_read_b64_tr_b16 v[78:79], v20 offset:9216
    v_mfma_f32_16x16x32_bf16 v[104:107], v[56:59], v[28:31], v[104:107]
    ds_read_b64_tr_b16 v[80:81], v21 offset:8192
    v_mfma_f32_16x16x32_bf16 v[92:95], v[44:47], v[28:31], v[92:95]
    ds_read_b64_tr_b16 v[82:83], v21 offset:9216
    s_waitcnt lgkmcnt(6)
    v_mfma_f32_16x16x32_bf16 v[112:115], v[48:51], v[32:35], v[112:115]
    ds_read_b64_tr_b16 v[84:85], v22 offset:8192
    v_mfma_f32_16x16x32_bf16 v[116:119], v[52:55], v[32:35], v[116:119]
    ds_read_b64_tr_b16 v[86:87], v22 offset:9216
    v_mfma_f32_16x16x32_bf16 v[120:123], v[56:59], v[32:35], v[120:123]
    ds_read_b64_tr_b16 v[88:89], v23 offset:8192
    v_mfma_f32_16x16x32_bf16 v[108:111], v[44:47], v[32:35], v[108:111]
    ds_read_b64_tr_b16 v[90:91], v23 offset:9216
    s_waitcnt lgkmcnt(9)
    v_mfma_f32_16x16x32_bf16 v[128:131], v[48:51], v[36:39], v[128:131]
    ds_read_b128 v[60:63], v17 offset:0
    v_mfma_f32_16x16x32_bf16 v[132:135], v[52:55], v[36:39], v[132:135]
    v_mfma_f32_16x16x32_bf16 v[136:139], v[56:59], v[36:39], v[136:139]
    ds_read_b128 v[64:67], v17 offset:2048
    v_mfma_f32_16x16x32_bf16 v[124:127], v[44:47], v[36:39], v[124:127]
    s_waitcnt lgkmcnt(10)
    v_mfma_f32_16x16x32_bf16 v[144:147], v[48:51], v[40:43], v[144:147]
    ds_read_b128 v[68:71], v17 offset:4096
    v_mfma_f32_16x16x32_bf16 v[148:151], v[52:55], v[40:43], v[148:151]
    v_mfma_f32_16x16x32_bf16 v[152:155], v[56:59], v[40:43], v[152:155]
    ds_read_b128 v[72:75], v17 offset:6144
    v_mfma_f32_16x16x32_bf16 v[140:143], v[44:47], v[40:43], v[140:143]
    s_barrier
    s_waitcnt lgkmcnt(3)
    v_mfma_f32_16x16x32_bf16 v[96:99], v[80:83], v[60:63], v[96:99]
    ds_read_b64_tr_b16 v[44:45], v20 offset:32768
    v_mfma_f32_16x16x32_bf16 v[100:103], v[84:87], v[60:63], v[100:103]
    ds_read_b64_tr_b16 v[46:47], v20 offset:33792
    v_mfma_f32_16x16x32_bf16 v[104:107], v[88:91], v[60:63], v[104:107]
    ds_read_b64_tr_b16 v[48:49], v21 offset:32768
    v_mfma_f32_16x16x32_bf16 v[92:95], v[76:79], v[60:63], v[92:95]
    ds_read_b64_tr_b16 v[50:51], v21 offset:33792
    s_waitcnt lgkmcnt(6)
    v_mfma_f32_16x16x32_bf16 v[112:115], v[80:83], v[64:67], v[112:115]
    ds_read_b64_tr_b16 v[52:53], v22 offset:32768
    v_mfma_f32_16x16x32_bf16 v[116:119], v[84:87], v[64:67], v[116:119]
    ds_read_b64_tr_b16 v[54:55], v22 offset:33792
    v_mfma_f32_16x16x32_bf16 v[120:123], v[88:91], v[64:67], v[120:123]
    ds_read_b64_tr_b16 v[56:57], v23 offset:32768
    v_mfma_f32_16x16x32_bf16 v[108:111], v[76:79], v[64:67], v[108:111]
    ds_read_b64_tr_b16 v[58:59], v23 offset:33792
    s_waitcnt lgkmcnt(9)
    v_mfma_f32_16x16x32_bf16 v[128:131], v[80:83], v[68:71], v[128:131]
    ds_read_b128 v[28:31], v16 offset:32768
    v_mfma_f32_16x16x32_bf16 v[132:135], v[84:87], v[68:71], v[132:135]
    v_mfma_f32_16x16x32_bf16 v[136:139], v[88:91], v[68:71], v[136:139]
    ds_read_b128 v[32:35], v16 offset:34816
    v_mfma_f32_16x16x32_bf16 v[124:127], v[76:79], v[68:71], v[124:127]
    s_waitcnt lgkmcnt(10)
    v_mfma_f32_16x16x32_bf16 v[144:147], v[80:83], v[72:75], v[144:147]
    ds_read_b128 v[36:39], v16 offset:36864
    v_mfma_f32_16x16x32_bf16 v[148:151], v[84:87], v[72:75], v[148:151]
    v_mfma_f32_16x16x32_bf16 v[152:155], v[88:91], v[72:75], v[152:155]
    ds_read_b128 v[40:43], v16 offset:38912
    v_mfma_f32_16x16x32_bf16 v[140:143], v[76:79], v[72:75], v[140:143]
    s_waitcnt lgkmcnt(3)
    v_mfma_f32_16x16x32_bf16 v[96:99], v[48:51], v[28:31], v[96:99]
    ds_read_b64_tr_b16 v[76:77], v20 offset:40960
    v_mfma_f32_16x16x32_bf16 v[100:103], v[52:55], v[28:31], v[100:103]
    ds_read_b64_tr_b16 v[78:79], v20 offset:41984
    v_mfma_f32_16x16x32_bf16 v[104:107], v[56:59], v[28:31], v[104:107]
    ds_read_b64_tr_b16 v[80:81], v21 offset:40960
    v_mfma_f32_16x16x32_bf16 v[92:95], v[44:47], v[28:31], v[92:95]
    ds_read_b64_tr_b16 v[82:83], v21 offset:41984
    s_waitcnt lgkmcnt(6)
    v_mfma_f32_16x16x32_bf16 v[112:115], v[48:51], v[32:35], v[112:115]
    ds_read_b64_tr_b16 v[84:85], v22 offset:40960
    v_mfma_f32_16x16x32_bf16 v[116:119], v[52:55], v[32:35], v[116:119]
    ds_read_b64_tr_b16 v[86:87], v22 offset:41984
    v_mfma_f32_16x16x32_bf16 v[120:123], v[56:59], v[32:35], v[120:123]
    ds_read_b64_tr_b16 v[88:89], v23 offset:40960
    v_mfma_f32_16x16x32_bf16 v[108:111], v[44:47], v[32:35], v[108:111]
    ds_read_b64_tr_b16 v[90:91], v23 offset:41984
    s_waitcnt lgkmcnt(9)
    v_mfma_f32_16x16x32_bf16 v[128:131], v[48:51], v[36:39], v[128:131]
    ds_read_b128 v[60:63], v17 offset:32768
    v_mfma_f32_16x16x32_bf16 v[132:135], v[52:55], v[36:39], v[132:135]
    v_mfma_f32_16x16x32_bf16 v[136:139], v[56:59], v[36:39], v[136:139]
    ds_read_b128 v[64:67], v17 offset:34816
    v_mfma_f32_16x16x32_bf16 v[124:127], v[44:47], v[36:39], v[124:127]
    s_waitcnt lgkmcnt(10)
    v_mfma_f32_16x16x32_bf16 v[144:147], v[48:51], v[40:43], v[144:147]
    ds_read_b128 v[68:71], v17 offset:36864
    v_mfma_f32_16x16x32_bf16 v[148:151], v[52:55], v[40:43], v[148:151]
    v_mfma_f32_16x16x32_bf16 v[152:155], v[56:59], v[40:43], v[152:155]
    ds_read_b128 v[72:75], v17 offset:38912
    v_mfma_f32_16x16x32_bf16 v[140:143], v[44:47], v[40:43], v[140:143]
    s_barrier
    s_waitcnt lgkmcnt(3)
    v_mfma_f32_16x16x32_bf16 v[96:99], v[80:83], v[60:63], v[96:99]
    ds_read_b64_tr_b16 v[44:45], v24 offset:0
    v_mfma_f32_16x16x32_bf16 v[100:103], v[84:87], v[60:63], v[100:103]
    ds_read_b64_tr_b16 v[46:47], v24 offset:1024
    v_mfma_f32_16x16x32_bf16 v[104:107], v[88:91], v[60:63], v[104:107]
    ds_read_b64_tr_b16 v[48:49], v25 offset:0
    v_mfma_f32_16x16x32_bf16 v[92:95], v[76:79], v[60:63], v[92:95]
    ds_read_b64_tr_b16 v[50:51], v25 offset:1024
    s_waitcnt lgkmcnt(6)
    v_mfma_f32_16x16x32_bf16 v[112:115], v[80:83], v[64:67], v[112:115]
    ds_read_b64_tr_b16 v[52:53], v26 offset:0
    v_mfma_f32_16x16x32_bf16 v[116:119], v[84:87], v[64:67], v[116:119]
    ds_read_b64_tr_b16 v[54:55], v26 offset:1024
    v_mfma_f32_16x16x32_bf16 v[120:123], v[88:91], v[64:67], v[120:123]
    ds_read_b64_tr_b16 v[56:57], v27 offset:0
    v_mfma_f32_16x16x32_bf16 v[108:111], v[76:79], v[64:67], v[108:111]
    ds_read_b64_tr_b16 v[58:59], v27 offset:1024
    s_waitcnt lgkmcnt(9)
    v_mfma_f32_16x16x32_bf16 v[128:131], v[80:83], v[68:71], v[128:131]
    ds_read_b128 v[28:31], v18 offset:0
    v_mfma_f32_16x16x32_bf16 v[132:135], v[84:87], v[68:71], v[132:135]
    v_mfma_f32_16x16x32_bf16 v[136:139], v[88:91], v[68:71], v[136:139]
    ds_read_b128 v[32:35], v18 offset:2048
    v_mfma_f32_16x16x32_bf16 v[124:127], v[76:79], v[68:71], v[124:127]
    s_waitcnt lgkmcnt(10)
    v_mfma_f32_16x16x32_bf16 v[144:147], v[80:83], v[72:75], v[144:147]
    ds_read_b128 v[36:39], v18 offset:4096
    v_mfma_f32_16x16x32_bf16 v[148:151], v[84:87], v[72:75], v[148:151]
    v_mfma_f32_16x16x32_bf16 v[152:155], v[88:91], v[72:75], v[152:155]
    ds_read_b128 v[40:43], v18 offset:6144
    v_mfma_f32_16x16x32_bf16 v[140:143], v[76:79], v[72:75], v[140:143]
    s_waitcnt lgkmcnt(3)
    v_mfma_f32_16x16x32_bf16 v[96:99], v[48:51], v[28:31], v[96:99]
    ds_read_b64_tr_b16 v[76:77], v24 offset:8192
    v_mfma_f32_16x16x32_bf16 v[100:103], v[52:55], v[28:31], v[100:103]
    ds_read_b64_tr_b16 v[78:79], v24 offset:9216
    v_mfma_f32_16x16x32_bf16 v[104:107], v[56:59], v[28:31], v[104:107]
    ds_read_b64_tr_b16 v[80:81], v25 offset:8192
    v_mfma_f32_16x16x32_bf16 v[92:95], v[44:47], v[28:31], v[92:95]
    ds_read_b64_tr_b16 v[82:83], v25 offset:9216
    s_waitcnt lgkmcnt(6)
    v_mfma_f32_16x16x32_bf16 v[112:115], v[48:51], v[32:35], v[112:115]
    ds_read_b64_tr_b16 v[84:85], v26 offset:8192
    v_mfma_f32_16x16x32_bf16 v[116:119], v[52:55], v[32:35], v[116:119]
    ds_read_b64_tr_b16 v[86:87], v26 offset:9216
    v_mfma_f32_16x16x32_bf16 v[120:123], v[56:59], v[32:35], v[120:123]
    ds_read_b64_tr_b16 v[88:89], v27 offset:8192
    v_mfma_f32_16x16x32_bf16 v[108:111], v[44:47], v[32:35], v[108:111]
    ds_read_b64_tr_b16 v[90:91], v27 offset:9216
    s_waitcnt lgkmcnt(9)
    v_mfma_f32_16x16x32_bf16 v[128:131], v[48:51], v[36:39], v[128:131]
    ds_read_b128 v[60:63], v19 offset:0
    v_mfma_f32_16x16x32_bf16 v[132:135], v[52:55], v[36:39], v[132:135]
    v_mfma_f32_16x16x32_bf16 v[136:139], v[56:59], v[36:39], v[136:139]
    ds_read_b128 v[64:67], v19 offset:2048
    v_mfma_f32_16x16x32_bf16 v[124:127], v[44:47], v[36:39], v[124:127]
    s_waitcnt lgkmcnt(10)
    v_mfma_f32_16x16x32_bf16 v[144:147], v[48:51], v[40:43], v[144:147]
    ds_read_b128 v[68:71], v19 offset:4096
    v_mfma_f32_16x16x32_bf16 v[148:151], v[52:55], v[40:43], v[148:151]
    v_mfma_f32_16x16x32_bf16 v[152:155], v[56:59], v[40:43], v[152:155]
    ds_read_b128 v[72:75], v19 offset:6144
    v_mfma_f32_16x16x32_bf16 v[140:143], v[44:47], v[40:43], v[140:143]
    s_barrier
    s_waitcnt lgkmcnt(3)
    v_mfma_f32_16x16x32_bf16 v[96:99], v[80:83], v[60:63], v[96:99]
    ds_read_b64_tr_b16 v[44:45], v24 offset:32768
    v_mfma_f32_16x16x32_bf16 v[100:103], v[84:87], v[60:63], v[100:103]
    ds_read_b64_tr_b16 v[46:47], v24 offset:33792
    v_mfma_f32_16x16x32_bf16 v[104:107], v[88:91], v[60:63], v[104:107]
    ds_read_b64_tr_b16 v[48:49], v25 offset:32768
    v_mfma_f32_16x16x32_bf16 v[92:95], v[76:79], v[60:63], v[92:95]
    ds_read_b64_tr_b16 v[50:51], v25 offset:33792
    s_waitcnt lgkmcnt(6)
    v_mfma_f32_16x16x32_bf16 v[112:115], v[80:83], v[64:67], v[112:115]
    ds_read_b64_tr_b16 v[52:53], v26 offset:32768
    v_mfma_f32_16x16x32_bf16 v[116:119], v[84:87], v[64:67], v[116:119]
    ds_read_b64_tr_b16 v[54:55], v26 offset:33792
    v_mfma_f32_16x16x32_bf16 v[120:123], v[88:91], v[64:67], v[120:123]
    ds_read_b64_tr_b16 v[56:57], v27 offset:32768
    v_mfma_f32_16x16x32_bf16 v[108:111], v[76:79], v[64:67], v[108:111]
    ds_read_b64_tr_b16 v[58:59], v27 offset:33792
    s_waitcnt lgkmcnt(9)
    v_mfma_f32_16x16x32_bf16 v[128:131], v[80:83], v[68:71], v[128:131]
    ds_read_b128 v[28:31], v18 offset:32768
    v_mfma_f32_16x16x32_bf16 v[132:135], v[84:87], v[68:71], v[132:135]
    v_mfma_f32_16x16x32_bf16 v[136:139], v[88:91], v[68:71], v[136:139]
    ds_read_b128 v[32:35], v18 offset:34816
    v_mfma_f32_16x16x32_bf16 v[124:127], v[76:79], v[68:71], v[124:127]
    s_waitcnt lgkmcnt(10)
    v_mfma_f32_16x16x32_bf16 v[144:147], v[80:83], v[72:75], v[144:147]
    ds_read_b128 v[36:39], v18 offset:36864
    v_mfma_f32_16x16x32_bf16 v[148:151], v[84:87], v[72:75], v[148:151]
    v_mfma_f32_16x16x32_bf16 v[152:155], v[88:91], v[72:75], v[152:155]
    ds_read_b128 v[40:43], v18 offset:38912
    v_mfma_f32_16x16x32_bf16 v[140:143], v[76:79], v[72:75], v[140:143]
    s_cmp_lg_u32 s21, 0
    s_cbranch_scc1 L_k1b_last
    s_waitcnt lgkmcnt(3)
    v_mfma_f32_16x16x32_bf16 v[96:99], v[48:51], v[28:31], v[96:99]
    ds_read_b64_tr_b16 v[76:77], v24 offset:40960
    v_mfma_f32_16x16x32_bf16 v[100:103], v[52:55], v[28:31], v[100:103]
    ds_read_b64_tr_b16 v[78:79], v24 offset:41984
    v_mfma_f32_16x16x32_bf16 v[104:107], v[56:59], v[28:31], v[104:107]
    ds_read_b64_tr_b16 v[80:81], v25 offset:40960
    v_mfma_f32_16x16x32_bf16 v[92:95], v[44:47], v[28:31], v[92:95]
    ds_read_b64_tr_b16 v[82:83], v25 offset:41984
    s_waitcnt lgkmcnt(6)
    v_mfma_f32_16x16x32_bf16 v[112:115], v[48:51], v[32:35], v[112:115]
    ds_read_b64_tr_b16 v[84:85], v26 offset:40960
    v_mfma_f32_16x16x32_bf16 v[116:119], v[52:55], v[32:35], v[116:119]
    ds_read_b64_tr_b16 v[86:87], v26 offset:41984
    v_mfma_f32_16x16x32_bf16 v[120:123], v[56:59], v[32:35], v[120:123]
    ds_read_b64_tr_b16 v[88:89], v27 offset:40960
    v_mfma_f32_16x16x32_bf16 v[108:111], v[44:47], v[32:35], v[108:111]
    ds_read_b64_tr_b16 v[90:91], v27 offset:41984
    s_waitcnt lgkmcnt(9)
    v_mfma_f32_16x16x32_bf16 v[128:131], v[48:51], v[36:39], v[128:131]
    ds_read_b128 v[60:63], v19 offset:32768
    v_mfma_f32_16x16x32_bf16 v[132:135], v[52:55], v[36:39], v[132:135]
    v_mfma_f32_16x16x32_bf16 v[136:139], v[56:59], v[36:39], v[136:139]
    ds_read_b128 v[64:67], v19 offset:34816
    v_mfma_f32_16x16x32_bf16 v[124:127], v[44:47], v[36:39], v[124:127]
    s_waitcnt lgkmcnt(10)
    v_mfma_f32_16x16x32_bf16 v[144:147], v[48:51], v[40:43], v[144:147]
    ds_read_b128 v[68:71], v19 offset:36864
    v_mfma_f32_16x16x32_bf16 v[148:151], v[52:55], v[40:43], v[148:151]
    v_mfma_f32_16x16x32_bf16 v[152:155], v[56:59], v[40:43], v[152:155]
    ds_read_b128 v[72:75], v19 offset:38912
    v_mfma_f32_16x16x32_bf16 v[140:143], v[44:47], v[40:43], v[140:143]
    s_barrier
    s_waitcnt lgkmcnt(3)
    v_mfma_f32_16x16x32_bf16 v[96:99], v[80:83], v[60:63], v[96:99]
    ds_read_b64_tr_b16 v[44:45], v20 offset:0
    v_mfma_f32_16x16x32_bf16 v[100:103], v[84:87], v[60:63], v[100:103]
    ds_read_b64_tr_b16 v[46:47], v20 offset:1024
    v_mfma_f32_16x16x32_bf16 v[104:107], v[88:91], v[60:63], v[104:107]
    ds_read_b64_tr_b16 v[48:49], v21 offset:0
    v_mfma_f32_16x16x32_bf16 v[92:95], v[76:79], v[60:63], v[92:95]
    ds_read_b64_tr_b16 v[50:51], v21 offset:1024
    s_waitcnt lgkmcnt(6)
    v_mfma_f32_16x16x32_bf16 v[112:115], v[80:83], v[64:67], v[112:115]
    ds_read_b64_tr_b16 v[52:53], v22 offset:0
    v_mfma_f32_16x16x32_bf16 v[116:119], v[84:87], v[64:67], v[116:119]
    ds_read_b64_tr_b16 v[54:55], v22 offset:1024
    v_mfma_f32_16x16x32_bf16 v[120:123], v[88:91], v[64:67], v[120:123]
    ds_read_b64_tr_b16 v[56:57], v23 offset:0
    v_mfma_f32_16x16x32_bf16 v[108:111], v[76:79], v[64:67], v[108:111]
    ds_read_b64_tr_b16 v[58:59], v23 offset:1024
    s_waitcnt lgkmcnt(9)
    v_mfma_f32_16x16x32_bf16 v[128:131], v[80:83], v[68:71], v[128:131]
    ds_read_b128 v[28:31], v16 offset:0
    v_mfma_f32_16x16x32_bf16 v[132:135], v[84:87], v[68:71], v[132:135]
    v_mfma_f32_16x16x32_bf16 v[136:139], v[88:91], v[68:71], v[136:139]
    ds_read_b128 v[32:35], v16 offset:2048
    v_mfma_f32_16x16x32_bf16 v[124:127], v[76:79], v[68:71], v[124:127]
    s_waitcnt lgkmcnt(10)
    v_mfma_f32_16x16x32_bf16 v[144:147], v[80:83], v[72:75], v[144:147]
    ds_read_b128 v[36:39], v16 offset:4096
    v_mfma_f32_16x16x32_bf16 v[148:151], v[84:87], v[72:75], v[148:151]
    v_mfma_f32_16x16x32_bf16 v[152:155], v[88:91], v[72:75], v[152:155]
    ds_read_b128 v[40:43], v16 offset:6144
    v_mfma_f32_16x16x32_bf16 v[140:143], v[76:79], v[72:75], v[140:143]
    s_mov_b32 s21, 1
    s_branch L_k1b_loop
L_k1b_last:
    s_waitcnt lgkmcnt(3)
    v_mfma_f32_16x16x32_bf16 v[96:99], v[48:51], v[28:31], v[96:99]
    ds_read_b64_tr_b16 v[76:77], v24 offset:40960
    v_mfma_f32_16x16x32_bf16 v[100:103], v[52:55], v[28:31], v[100:103]
    ds_read_b64_tr_b16 v[78:79], v24 offset:41984
    v_mfma_f32_16x16x32_bf16 v[104:107], v[56:59], v[28:31], v[104:107]
    ds_read_b64_tr_b16 v[80:81], v25 offset:40960
    v_mfma_f32_16x16x32_bf16 v[92:95], v[44:47], v[28:31], v[92:95]
    ds_read_b64_tr_b16 v[82:83], v25 offset:41984
    s_waitcnt lgkmcnt(6)
    v_mfma_f32_16x16x32_bf16 v[112:115], v[48:51], v[32:35], v[112:115]
    ds_read_b64_tr_b16 v[84:85], v26 offset:40960
    v_mfma_f32_16x16x32_bf16 v[116:119], v[52:55], v[32:35], v[116:119]
    ds_read_b64_tr_b16 v[86:87], v26 offset:41984
    v_mfma_f32_16x16x32_bf16 v[120:123], v[56:59], v[32:35], v[120:123]
    ds_read_b64_tr_b16 v[88:89], v27 offset:40960
    v_mfma_f32_16x16x32_bf16 v[108:111], v[44:47], v[32:35], v[108:111]
    ds_read_b64_tr_b16 v[90:91], v27 offset:41984
    s_waitcnt lgkmcnt(9)
    v_mfma_f32_16x16x32_bf16 v[128:131], v[48:51], v[36:39], v[128:131]
    ds_read_b128 v[60:63], v19 offset:32768
    v_mfma_f32_16x16x32_bf16 v[132:135], v[52:55], v[36:39], v[132:135]
    v_mfma_f32_16x16x32_bf16 v[136:139], v[56:59], v[36:39], v[136:139]
    ds_read_b128 v[64:67], v19 offset:34816
    v_mfma_f32_16x16x32_bf16 v[124:127], v[44:47], v[36:39], v[124:127]
    s_waitcnt lgkmcnt(10)
    v_mfma_f32_16x16x32_bf16 v[144:147], v[48:51], v[40:43], v[144:147]
    ds_read_b128 v[68:71], v19 offset:36864
    v_mfma_f32_16x16x32_bf16 v[148:151], v[52:55], v[40:43], v[148:151]
    v_mfma_f32_16x16x32_bf16 v[152:155], v[56:59], v[40:43], v[152:155]
    ds_read_b128 v[72:75], v19 offset:38912
    v_mfma_f32_16x16x32_bf16 v[140:143], v[44:47], v[40:43], v[140:143]
    s_waitcnt lgkmcnt(3)
    v_mfma_f32_16x16x32_bf16 v[96:99], v[80:83], v[60:63], v[96:99]
    v_mfma_f32_16x16x32_bf16 v[100:103], v[84:87], v[60:63], v[100:103]
    v_mfma_f32_16x16x32_bf16 v[104:107], v[88:91], v[60:63], v[104:107]
    v_mfma_f32_16x16x32_bf16 v[92:95], v[76:79], v[60:63], v[92:95]
    s_waitcnt lgkmcnt(2)
    v_mfma_f32_16x16x32_bf16 v[112:115], v[80:83], v[64:67], v[112:115]
    v_mfma_f32_16x16x32_bf16 v[116:119], v[84:87], v[64:67], v[116:119]
    v_mfma_f32_16x16x32_bf16 v[120:123], v[88:91], v[64:67], v[120:123]
    v_mfma_f32_16x16x32_bf16 v[108:111], v[76:79], v[64:67], v[108:111]
    s_waitcnt lgkmcnt(1)
    v_mfma_f32_16x16x32_bf16 v[128:131], v[80:83], v[68:71], v[128:131]
    v_mfma_f32_16x16x32_bf16 v[132:135], v[84:87], v[68:71], v[132:135]
    v_mfma_f32_16x16x32_bf16 v[136:139], v[88:91], v[68:71], v[136:139]
    v_mfma_f32_16x16x32_bf16 v[124:127], v[76:79], v[68:71], v[124:127]
    s_waitcnt lgkmcnt(0)
    v_mfma_f32_16x16x32_bf16 v[144:147], v[80:83], v[72:75], v[144:147]
    s_waitcnt lgkmcnt(0)
    s_barrier
    ds_read_b128 v[160:163], v5 offset:0
    ds_read_b128 v[164:167], v5 offset:64
    ds_read_b128 v[168:171], v5 offset:128
    ds_read_b128 v[172:175], v5 offset:192
    ds_read_b32 v14, v7
    ds_read_b32 v28, v6 offset:0
    ds_read_b32 v44, v6 offset:256
    ds_read_b32 v29, v6 offset:64
    ds_read_b32 v45, v6 offset:320
    ds_read_b32 v30, v6 offset:128
    ds_read_b32 v46, v6 offset:384
    ds_read_b32 v31, v6 offset:192
    ds_read_b32 v47, v6 offset:448
    v_mfma_f32_16x16x32_bf16 v[148:151], v[84:87], v[72:75], v[148:151]
    v_mfma_f32_16x16x32_bf16 v[152:155], v[88:91], v[72:75], v[152:155]
    v_mfma_f32_16x16x32_bf16 v[140:143], v[76:79], v[72:75], v[140:143]
    s_setprio 2
    s_waitcnt vmcnt(0) lgkmcnt(0)
    v_readfirstlane_b32 s63, v14
    s_nop 3
    v_mov_b32 v68, 0xc0135761
    v_mov_b32 v69, 0xbdd2d3e8
    v_mov_b32 v70, 1.0
    v_lshlrev_b32 v5, 4, v1
    s_lshl_b32 s22, s29, 4
    s_add_u32 s22, s22, s28
    s_add_u32 s22, s22, s34
    s_mul_i32 s22, s22, 43
    s_lshr_b32 s23, s33, 6
    s_add_u32 s22, s22, s23
    s_lshl_b32 s22, s22, 12
    v_lshlrev_b32 v72, 16, v184
    v_and_b32 v73, 0xffff0000, v184
    v_lshlrev_b32 v74, 16, v185
    v_and_b32 v75, 0xffff0000, v185
    v_lshlrev_b32 v76, 16, v186
    v_and_b32 v77, 0xffff0000, v186
    v_lshlrev_b32 v78, 16, v187
    v_and_b32 v79, 0xffff0000, v187
    v_pk_fma_f32 v[80:81], v[44:45], v[160:161], v[72:73] op_sel:[0,0,0] op_sel_hi:[0,1,1] neg_lo:[1,0,0] neg_hi:[1,0,0]
    v_pk_fma_f32 v[82:83], v[44:45], v[162:163], v[74:75] op_sel:[0,0,0] op_sel_hi:[0,1,1] neg_lo:[1,0,0] neg_hi:[1,0,0]
    v_pk_fma_f32 v[84:85], v[44:45], v[164:165], v[76:77] op_sel:[0,0,0] op_sel_hi:[0,1,1] neg_lo:[1,0,0] neg_hi:[1,0,0]
    v_pk_fma_f32 v[86:87], v[44:45], v[166:167], v[78:79] op_sel:[0,0,0] op_sel_hi:[0,1,1] neg_lo:[1,0,0] neg_hi:[1,0,0]
    v_pk_fma_f32 v[92:93], v[28:29], v[92:93], v[80:81] op_sel:[0,0,0] op_sel_hi:[0,1,1]
    v_pk_fma_f32 v[94:95], v[28:29], v[94:95], v[82:83] op_sel:[0,0,0] op_sel_hi:[0,1,1]
    v_pk_fma_f32 v[96:97], v[28:29], v[96:97], v[84:85] op_sel:[0,0,0] op_sel_hi:[0,1,1]
    v_pk_fma_f32 v[98:99], v[28:29], v[98:99], v[86:87] op_sel:[0,0,0] op_sel_hi:[0,1,1]
    v_pk_mul_f32 v[80:81], v[92:93], v[92:93]
    v_pk_mul_f32 v[82:83], v[94:95], v[94:95]
    v_pk_mul_f32 v[84:85], v[96:97], v[96:97]
    v_pk_mul_f32 v[86:87], v[98:99], v[98:99]
    v_pk_fma_f32 v[80:81], v[80:81], v[68:69], v[68:69] op_sel:[0,1,0] op_sel_hi:[1,1,0]
    v_pk_fma_f32 v[82:83], v[82:83], v[68:69], v[68:69] op_sel:[0,1,0] op_sel_hi:[1,1,0]
    v_pk_fma_f32 v[84:85], v[84:85], v[68:69], v[68:69] op_sel:[0,1,0] op_sel_hi:[1,1,0]
    v_pk_fma_f32 v[86:87], v[86:87], v[68:69], v[68:69] op_sel:[0,1,0] op_sel_hi:[1,1,0]
    v_pk_mul_f32 v[80:81], v[80:81], v[92:93]
    v_pk_mul_f32 v[82:83], v[82:83], v[94:95]
    v_pk_mul_f32 v[84:85], v[84:85], v[96:97]
    v_pk_mul_f32 v[86:87], v[86:87], v[98:99]
    v_exp_f32 v80, v80
    v_exp_f32 v81, v81
    v_exp_f32 v82, v82
    v_exp_f32 v83, v83
    v_exp_f32 v84, v84
    v_exp_f32 v85, v85
    v_exp_f32 v86, v86
    v_exp_f32 v87, v87
    v_pk_add_f32 v[80:81], v[80:81], v[70:71] op_sel_hi:[1,0]
    v_pk_add_f32 v[82:83], v[82:83], v[70:71] op_sel_hi:[1,0]
    v_pk_add_f32 v[84:85], v[84:85], v[70:71] op_sel_hi:[1,0]
    v_pk_add_f32 v[86:87], v[86:87], v[70:71] op_sel_hi:[1,0]
    v_rcp_f32 v80, v80
    v_rcp_f32 v81, v81
    v_rcp_f32 v82, v82
    v_rcp_f32 v83, v83
    v_rcp_f32 v84, v84
    v_rcp_f32 v85, v85
    v_rcp_f32 v86, v86
    v_rcp_f32 v87, v87
    v_pk_mul_f32 v[80:81], v[80:81], v[92:93]
    v_pk_mul_f32 v[82:83], v[82:83], v[94:95]
    v_pk_mul_f32 v[84:85], v[84:85], v[96:97]
    v_pk_mul_f32 v[86:87], v[86:87], v[98:99]
    v_cvt_pk_bf16_f32 v92, v80, v81
    v_cvt_pk_bf16_f32 v93, v82, v83
    v_cvt_pk_bf16_f32 v94, v84, v85
    v_cvt_pk_bf16_f32 v95, v86, v87
    buffer_store_dwordx4 v[92:95], v5, s[24:27], s22 offen offset:0 sc1
    v_pk_fma_f32 v[80:81], v[44:45], v[160:161], v[72:73] op_sel:[1,0,0] op_sel_hi:[1,1,1] neg_lo:[1,0,0] neg_hi:[1,0,0]
    v_pk_fma_f32 v[82:83], v[44:45], v[162:163], v[74:75] op_sel:[1,0,0] op_sel_hi:[1,1,1] neg_lo:[1,0,0] neg_hi:[1,0,0]
    v_pk_fma_f32 v[84:85], v[44:45], v[164:165], v[76:77] op_sel:[1,0,0] op_sel_hi:[1,1,1] neg_lo:[1,0,0] neg_hi:[1,0,0]
    v_pk_fma_f32 v[86:87], v[44:45], v[166:167], v[78:79] op_sel:[1,0,0] op_sel_hi:[1,1,1] neg_lo:[1,0,0] neg_hi:[1,0,0]
    v_pk_fma_f32 v[108:109], v[28:29], v[108:109], v[80:81] op_sel:[1,0,0] op_sel_hi:[1,1,1]
    v_pk_fma_f32 v[110:111], v[28:29], v[110:111], v[82:83] op_sel:[1,0,0] op_sel_hi:[1,1,1]
    v_pk_fma_f32 v[112:113], v[28:29], v[112:113], v[84:85] op_sel:[1,0,0] op_sel_hi:[1,1,1]
    v_pk_fma_f32 v[114:115], v[28:29], v[114:115], v[86:87] op_sel:[1,0,0] op_sel_hi:[1,1,1]
    v_pk_mul_f32 v[80:81], v[108:109], v[108:109]
    v_pk_mul_f32 v[82:83], v[110:111], v[110:111]
    v_pk_mul_f32 v[84:85], v[112:113], v[112:113]
    v_pk_mul_f32 v[86:87], v[114:115], v[114:115]
    v_pk_fma_f32 v[80:81], v[80:81], v[68:69], v[68:69] op_sel:[0,1,0] op_sel_hi:[1,1,0]
    v_pk_fma_f32 v[82:83], v[82:83], v[68:69], v[68:69] op_sel:[0,1,0] op_sel_hi:[1,1,0]
    v_pk_fma_f32 v[84:85], v[84:85], v[68:69], v[68:69] op_sel:[0,1,0] op_sel_hi:[1,1,0]
    v_pk_fma_f32 v[86:87], v[86:87], v[68:69], v[68:69] op_sel:[0,1,0] op_sel_hi:[1,1,0]
    v_pk_mul_f32 v[80:81], v[80:81], v[108:109]
    v_pk_mul_f32 v[82:83], v[82:83], v[110:111]
    v_pk_mul_f32 v[84:85], v[84:85], v[112:113]
    v_pk_mul_f32 v[86:87], v[86:87], v[114:115]
    v_exp_f32 v80, v80
    v_exp_f32 v81, v81
    v_exp_f32 v82, v82
    v_exp_f32 v83, v83
    v_exp_f32 v84, v84
    v_exp_f32 v85, v85
    v_exp_f32 v86, v86
    v_exp_f32 v87, v87
    v_pk_add_f32 v[80:81], v[80:81], v[70:71] op_sel_hi:[1,0]
    v_pk_add_f32 v[82:83], v[82:83], v[70:71] op_sel_hi:[1,0]
    v_pk_add_f32 v[84:85], v[84:85], v[70:71] op_sel_hi:[1,0]
    v_pk_add_f32 v[86:87], v[86:87], v[70:71] op_sel_hi:[1,0]
    v_rcp_f32 v80, v80
    v_rcp_f32 v81, v81
    v_rcp_f32 v82, v82
    v_rcp_f32 v83, v83
    v_rcp_f32 v84, v84
    v_rcp_f32 v85, v85
    v_rcp_f32 v86, v86
    v_rcp_f32 v87, v87
    v_pk_mul_f32 v[80:81], v[80:81], v[108:109]
    v_pk_mul_f32 v[82:83], v[82:83], v[110:111]
    v_pk_mul_f32 v[84:85], v[84:85], v[112:113]
    v_pk_mul_f32 v[86:87], v[86:87], v[114:115]
    v_cvt_pk_bf16_f32 v108, v80, v81
    v_cvt_pk_bf16_f32 v109, v82, v83
    v_cvt_pk_bf16_f32 v110, v84, v85
    v_cvt_pk_bf16_f32 v111, v86, v87
    buffer_store_dwordx4 v[108:111], v5, s[24:27], s22 offen offset:1024 sc1
    v_pk_fma_f32 v[80:81], v[46:47], v[160:161], v[72:73] op_sel:[0,0,0] op_sel_hi:[0,1,1] neg_lo:[1,0,0] neg_hi:[1,0,0]
    v_pk_fma_f32 v[82:83], v[46:47], v[162:163], v[74:75] op_sel:[0,0,0] op_sel_hi:[0,1,1] neg_lo:[1,0,0] neg_hi:[1,0,0]
    v_pk_fma_f32 v[84:85], v[46:47], v[164:165], v[76:77] op_sel:[0,0,0] op_sel_hi:[0,1,1] neg_lo:[1,0,0] neg_hi:[1,0,0]
    v_pk_fma_f32 v[86:87], v[46:47], v[166:167], v[78:79] op_sel:[0,0,0] op_sel_hi:[0,1,1] neg_lo:[1,0,0] neg_hi:[1,0,0]
    v_pk_fma_f32 v[124:125], v[30:31], v[124:125], v[80:81] op_sel:[0,0,0] op_sel_hi:[0,1,1]
    v_pk_fma_f32 v[126:127], v[30:31], v[126:127], v[82:83] op_sel:[0,0,0] op_sel_hi:[0,1,1]
    v_pk_fma_f32 v[128:129], v[30:31], v[128:129], v[84:85] op_sel:[0,0,0] op_sel_hi:[0,1,1]
    v_pk_fma_f32 v[130:131], v[30:31], v[130:131], v[86:87] op_sel:[0,0,0] op_sel_hi:[0,1,1]
    v_pk_mul_f32 v[80:81], v[124:125], v[124:125]
    v_pk_mul_f32 v[82:83], v[126:127], v[126:127]
    v_pk_mul_f32 v[84:85], v[128:129], v[128:129]
    v_pk_mul_f32 v[86:87], v[130:131], v[130:131]
    v_pk_fma_f32 v[80:81], v[80:81], v[68:69], v[68:69] op_sel:[0,1,0] op_sel_hi:[1,1,0]
    v_pk_fma_f32 v[82:83], v[82:83], v[68:69], v[68:69] op_sel:[0,1,0] op_sel_hi:[1,1,0]
    v_pk_fma_f32 v[84:85], v[84:85], v[68:69], v[68:69] op_sel:[0,1,0] op_sel_hi:[1,1,0]
    v_pk_fma_f32 v[86:87], v[86:87], v[68:69], v[68:69] op_sel:[0,1,0] op_sel_hi:[1,1,0]
    v_pk_mul_f32 v[80:81], v[80:81], v[124:125]
    v_pk_mul_f32 v[82:83], v[82:83], v[126:127]
    v_pk_mul_f32 v[84:85], v[84:85], v[128:129]
    v_pk_mul_f32 v[86:87], v[86:87], v[130:131]
    v_exp_f32 v80, v80
    v_exp_f32 v81, v81
    v_exp_f32 v82, v82
    v_exp_f32 v83, v83
    v_exp_f32 v84, v84
    v_exp_f32 v85, v85
    v_exp_f32 v86, v86
    v_exp_f32 v87, v87
    v_pk_add_f32 v[80:81], v[80:81], v[70:71] op_sel_hi:[1,0]
    v_pk_add_f32 v[82:83], v[82:83], v[70:71] op_sel_hi:[1,0]
    v_pk_add_f32 v[84:85], v[84:85], v[70:71] op_sel_hi:[1,0]
    v_pk_add_f32 v[86:87], v[86:87], v[70:71] op_sel_hi:[1,0]
    v_rcp_f32 v80, v80
    v_rcp_f32 v81, v81
    v_rcp_f32 v82, v82
    v_rcp_f32 v83, v83
    v_rcp_f32 v84, v84
    v_rcp_f32 v85, v85
    v_rcp_f32 v86, v86
    v_rcp_f32 v87, v87
    v_pk_mul_f32 v[80:81], v[80:81], v[124:125]
    v_pk_mul_f32 v[82:83], v[82:83], v[126:127]
    v_pk_mul_f32 v[84:85], v[84:85], v[128:129]
    v_pk_mul_f32 v[86:87], v[86:87], v[130:131]
    v_cvt_pk_bf16_f32 v124, v80, v81
    v_cvt_pk_bf16_f32 v125, v82, v83
    v_cvt_pk_bf16_f32 v126, v84, v85
    v_cvt_pk_bf16_f32 v127, v86, v87
    buffer_store_dwordx4 v[124:127], v5, s[24:27], s22 offen offset:2048 sc1
    v_pk_fma_f32 v[80:81], v[46:47], v[160:161], v[72:73] op_sel:[1,0,0] op_sel_hi:[1,1,1] neg_lo:[1,0,0] neg_hi:[1,0,0]
    v_pk_fma_f32 v[82:83], v[46:47], v[162:163], v[74:75] op_sel:[1,0,0] op_sel_hi:[1,1,1] neg_lo:[1,0,0] neg_hi:[1,0,0]
    v_pk_fma_f32 v[84:85], v[46:47], v[164:165], v[76:77] op_sel:[1,0,0] op_sel_hi:[1,1,1] neg_lo:[1,0,0] neg_hi:[1,0,0]
    v_pk_fma_f32 v[86:87], v[46:47], v[166:167], v[78:79] op_sel:[1,0,0] op_sel_hi:[1,1,1] neg_lo:[1,0,0] neg_hi:[1,0,0]
    v_pk_fma_f32 v[140:141], v[30:31], v[140:141], v[80:81] op_sel:[1,0,0] op_sel_hi:[1,1,1]
    v_pk_fma_f32 v[142:143], v[30:31], v[142:143], v[82:83] op_sel:[1,0,0] op_sel_hi:[1,1,1]
    v_pk_fma_f32 v[144:145], v[30:31], v[144:145], v[84:85] op_sel:[1,0,0] op_sel_hi:[1,1,1]
    v_pk_fma_f32 v[146:147], v[30:31], v[146:147], v[86:87] op_sel:[1,0,0] op_sel_hi:[1,1,1]
    v_pk_mul_f32 v[80:81], v[140:141], v[140:141]
    v_pk_mul_f32 v[82:83], v[142:143], v[142:143]
    v_pk_mul_f32 v[84:85], v[144:145], v[144:145]
    v_pk_mul_f32 v[86:87], v[146:147], v[146:147]
    v_pk_fma_f32 v[80:81], v[80:81], v[68:69], v[68:69] op_sel:[0,1,0] op_sel_hi:[1,1,0]
    v_pk_fma_f32 v[82:83], v[82:83], v[68:69], v[68:69] op_sel:[0,1,0] op_sel_hi:[1,1,0]
    v_pk_fma_f32 v[84:85], v[84:85], v[68:69], v[68:69] op_sel:[0,1,0] op_sel_hi:[1,1,0]
    v_pk_fma_f32 v[86:87], v[86:87], v[68:69], v[68:69] op_sel:[0,1,0] op_sel_hi:[1,1,0]
    v_pk_mul_f32 v[80:81], v[80:81], v[140:141]
    v_pk_mul_f32 v[82:83], v[82:83], v[142:143]
    v_pk_mul_f32 v[84:85], v[84:85], v[144:145]
    v_pk_mul_f32 v[86:87], v[86:87], v[146:147]
    v_exp_f32 v80, v80
    v_exp_f32 v81, v81
    v_exp_f32 v82, v82
    v_exp_f32 v83, v83
    v_exp_f32 v84, v84
    v_exp_f32 v85, v85
    v_exp_f32 v86, v86
    v_exp_f32 v87, v87
    v_pk_add_f32 v[80:81], v[80:81], v[70:71] op_sel_hi:[1,0]
    v_pk_add_f32 v[82:83], v[82:83], v[70:71] op_sel_hi:[1,0]
    v_pk_add_f32 v[84:85], v[84:85], v[70:71] op_sel_hi:[1,0]
    v_pk_add_f32 v[86:87], v[86:87], v[70:71] op_sel_hi:[1,0]
    v_rcp_f32 v80, v80
    v_rcp_f32 v81, v81
    v_rcp_f32 v82, v82
    v_rcp_f32 v83, v83
    v_rcp_f32 v84, v84
    v_rcp_f32 v85, v85
    v_rcp_f32 v86, v86
    v_rcp_f32 v87, v87
    v_pk_mul_f32 v[80:81], v[80:81], v[140:141]
    v_pk_mul_f32 v[82:83], v[82:83], v[142:143]
    v_pk_mul_f32 v[84:85], v[84:85], v[144:145]
    v_pk_mul_f32 v[86:87], v[86:87], v[146:147]
    v_cvt_pk_bf16_f32 v140, v80, v81
    v_cvt_pk_bf16_f32 v141, v82, v83
    v_cvt_pk_bf16_f32 v142, v84, v85
    v_cvt_pk_bf16_f32 v143, v86, v87
    buffer_store_dwordx4 v[140:143], v5, s[24:27], s22 offen offset:3072 sc1
    s_cmp_ge_u32 s23, 42
    s_cbranch_scc1 L_k1b_skip
    s_add_u32 s22, s22, 4096
    v_lshlrev_b32 v72, 16, v188
    v_and_b32 v73, 0xffff0000, v188
    v_lshlrev_b32 v74, 16, v189
    v_and_b32 v75, 0xffff0000, v189
    v_lshlrev_b32 v76, 16, v190
    v_and_b32 v77, 0xffff0000, v190
    v_lshlrev_b32 v78, 16, v191
    v_and_b32 v79, 0xffff0000, v191
    v_pk_fma_f32 v[80:81], v[44:45], v[168:169], v[72:73] op_sel:[0,0,0] op_sel_hi:[0,1,1] neg_lo:[1,0,0] neg_hi:[1,0,0]
    v_pk_fma_f32 v[82:83], v[44:45], v[170:171], v[74:75] op_sel:[0,0,0] op_sel_hi:[0,1,1] neg_lo:[1,0,0] neg_hi:[1,0,0]
    v_pk_fma_f32 v[84:85], v[44:45], v[172:173], v[76:77] op_sel:[0,0,0] op_sel_hi:[0,1,1] neg_lo:[1,0,0] neg_hi:[1,0,0]
    v_pk_fma_f32 v[86:87], v[44:45], v[174:175], v[78:79] op_sel:[0,0,0] op_sel_hi:[0,1,1] neg_lo:[1,0,0] neg_hi:[1,0,0]
    v_pk_fma_f32 v[100:101], v[28:29], v[100:101], v[80:81] op_sel:[0,0,0] op_sel_hi:[0,1,1]
    v_pk_fma_f32 v[102:103], v[28:29], v[102:103], v[82:83] op_sel:[0,0,0] op_sel_hi:[0,1,1]
    v_pk_fma_f32 v[104:105], v[28:29], v[104:105], v[84:85] op_sel:[0,0,0] op_sel_hi:[0,1,1]
    v_pk_fma_f32 v[106:107], v[28:29], v[106:107], v[86:87] op_sel:[0,0,0] op_sel_hi:[0,1,1]
    v_pk_mul_f32 v[80:81], v[100:101], v[100:101]
    v_pk_mul_f32 v[82:83], v[102:103], v[102:103]
    v_pk_mul_f32 v[84:85], v[104:105], v[104:105]
    v_pk_mul_f32 v[86:87], v[106:107], v[106:107]
    v_pk_fma_f32 v[80:81], v[80:81], v[68:69], v[68:69] op_sel:[0,1,0] op_sel_hi:[1,1,0]
    v_pk_fma_f32 v[82:83], v[82:83], v[68:69], v[68:69] op_sel:[0,1,0] op_sel_hi:[1,1,0]
    v_pk_fma_f32 v[84:85], v[84:85], v[68:69], v[68:69] op_sel:[0,1,0] op_sel_hi:[1,1,0]
    v_pk_fma_f32 v[86:87], v[86:87], v[68:69], v[68:69] op_sel:[0,1,0] op_sel_hi:[1,1,0]
    v_pk_mul_f32 v[80:81], v[80:81], v[100:101]
    v_pk_mul_f32 v[82:83], v[82:83], v[102:103]
    v_pk_mul_f32 v[84:85], v[84:85], v[104:105]
    v_pk_mul_f32 v[86:87], v[86:87], v[106:107]
    v_exp_f32 v80, v80
    v_exp_f32 v81, v81
    v_exp_f32 v82, v82
    v_exp_f32 v83, v83
    v_exp_f32 v84, v84
    v_exp_f32 v85, v85
    v_exp_f32 v86, v86
    v_exp_f32 v87, v87
    v_pk_add_f32 v[80:81], v[80:81], v[70:71] op_sel_hi:[1,0]
    v_pk_add_f32 v[82:83], v[82:83], v[70:71] op_sel_hi:[1,0]
    v_pk_add_f32 v[84:85], v[84:85], v[70:71] op_sel_hi:[1,0]
    v_pk_add_f32 v[86:87], v[86:87], v[70:71] op_sel_hi:[1,0]
    v_rcp_f32 v80, v80
    v_rcp_f32 v81, v81
    v_rcp_f32 v82, v82
    v_rcp_f32 v83, v83
    v_rcp_f32 v84, v84
    v_rcp_f32 v85, v85
    v_rcp_f32 v86, v86
    v_rcp_f32 v87, v87
    v_pk_mul_f32 v[80:81], v[80:81], v[100:101]
    v_pk_mul_f32 v[82:83], v[82:83], v[102:103]
    v_pk_mul_f32 v[84:85], v[84:85], v[104:105]
    v_pk_mul_f32 v[86:87], v[86:87], v[106:107]
    v_cvt_pk_bf16_f32 v100, v80, v81
    v_cvt_pk_bf16_f32 v101, v82, v83
    v_cvt_pk_bf16_f32 v102, v84, v85
    v_cvt_pk_bf16_f32 v103, v86, v87
    buffer_store_dwordx4 v[100:103], v5, s[24:27], s22 offen offset:0 sc1
    v_pk_fma_f32 v[80:81], v[44:45], v[168:169], v[72:73] op_sel:[1,0,0] op_sel_hi:[1,1,1] neg_lo:[1,0,0] neg_hi:[1,0,0]
    v_pk_fma_f32 v[82:83], v[44:45], v[170:171], v[74:75] op_sel:[1,0,0] op_sel_hi:[1,1,1] neg_lo:[1,0,0] neg_hi:[1,0,0]
    v_pk_fma_f32 v[84:85], v[44:45], v[172:173], v[76:77] op_sel:[1,0,0] op_sel_hi:[1,1,1] neg_lo:[1,0,0] neg_hi:[1,0,0]
    v_pk_fma_f32 v[86:87], v[44:45], v[174:175], v[78:79] op_sel:[1,0,0] op_sel_hi:[1,1,1] neg_lo:[1,0,0] neg_hi:[1,0,0]
    v_pk_fma_f32 v[116:117], v[28:29], v[116:117], v[80:81] op_sel:[1,0,0] op_sel_hi:[1,1,1]
    v_pk_fma_f32 v[118:119], v[28:29], v[118:119], v[82:83] op_sel:[1,0,0] op_sel_hi:[1,1,1]
    v_pk_fma_f32 v[120:121], v[28:29], v[120:121], v[84:85] op_sel:[1,0,0] op_sel_hi:[1,1,1]
    v_pk_fma_f32 v[122:123], v[28:29], v[122:123], v[86:87] op_sel:[1,0,0] op_sel_hi:[1,1,1]
    v_pk_mul_f32 v[80:81], v[116:117], v[116:117]
    v_pk_mul_f32 v[82:83], v[118:119], v[118:119]
    v_pk_mul_f32 v[84:85], v[120:121], v[120:121]
    v_pk_mul_f32 v[86:87], v[122:123], v[122:123]
    v_pk_fma_f32 v[80:81], v[80:81], v[68:69], v[68:69] op_sel:[0,1,0] op_sel_hi:[1,1,0]
    v_pk_fma_f32 v[82:83], v[82:83], v[68:69], v[68:69] op_sel:[0,1,0] op_sel_hi:[1,1,0]
    v_pk_fma_f32 v[84:85], v[84:85], v[68:69], v[68:69] op_sel:[0,1,0] op_sel_hi:[1,1,0]
    v_pk_fma_f32 v[86:87], v[86:87], v[68:69], v[68:69] op_sel:[0,1,0] op_sel_hi:[1,1,0]
    v_pk_mul_f32 v[80:81], v[80:81], v[116:117]
    v_pk_mul_f32 v[82:83], v[82:83], v[118:119]
    v_pk_mul_f32 v[84:85], v[84:85], v[120:121]
    v_pk_mul_f32 v[86:87], v[86:87], v[122:123]
    v_exp_f32 v80, v80
    v_exp_f32 v81, v81
    v_exp_f32 v82, v82
    v_exp_f32 v83, v83
    v_exp_f32 v84, v84
    v_exp_f32 v85, v85
    v_exp_f32 v86, v86
    v_exp_f32 v87, v87
    v_pk_add_f32 v[80:81], v[80:81], v[70:71] op_sel_hi:[1,0]
    v_pk_add_f32 v[82:83], v[82:83], v[70:71] op_sel_hi:[1,0]
    v_pk_add_f32 v[84:85], v[84:85], v[70:71] op_sel_hi:[1,0]
    v_pk_add_f32 v[86:87], v[86:87], v[70:71] op_sel_hi:[1,0]
    v_rcp_f32 v80, v80
    v_rcp_f32 v81, v81
    v_rcp_f32 v82, v82
    v_rcp_f32 v83, v83
    v_rcp_f32 v84, v84
    v_rcp_f32 v85, v85
    v_rcp_f32 v86, v86
    v_rcp_f32 v87, v87
    v_pk_mul_f32 v[80:81], v[80:81], v[116:117]
    v_pk_mul_f32 v[82:83], v[82:83], v[118:119]
    v_pk_mul_f32 v[84:85], v[84:85], v[120:121]
    v_pk_mul_f32 v[86:87], v[86:87], v[122:123]
    v_cvt_pk_bf16_f32 v116, v80, v81
    v_cvt_pk_bf16_f32 v117, v82, v83
    v_cvt_pk_bf16_f32 v118, v84, v85
    v_cvt_pk_bf16_f32 v119, v86, v87
    buffer_store_dwordx4 v[116:119], v5, s[24:27], s22 offen offset:1024 sc1
    v_pk_fma_f32 v[80:81], v[46:47], v[168:169], v[72:73] op_sel:[0,0,0] op_sel_hi:[0,1,1] neg_lo:[1,0,0] neg_hi:[1,0,0]
    v_pk_fma_f32 v[82:83], v[46:47], v[170:171], v[74:75] op_sel:[0,0,0] op_sel_hi:[0,1,1] neg_lo:[1,0,0] neg_hi:[1,0,0]
    v_pk_fma_f32 v[84:85], v[46:47], v[172:173], v[76:77] op_sel:[0,0,0] op_sel_hi:[0,1,1] neg_lo:[1,0,0] neg_hi:[1,0,0]
    v_pk_fma_f32 v[86:87], v[46:47], v[174:175], v[78:79] op_sel:[0,0,0] op_sel_hi:[0,1,1] neg_lo:[1,0,0] neg_hi:[1,0,0]
    v_pk_fma_f32 v[132:133], v[30:31], v[132:133], v[80:81] op_sel:[0,0,0] op_sel_hi:[0,1,1]
    v_pk_fma_f32 v[134:135], v[30:31], v[134:135], v[82:83] op_sel:[0,0,0] op_sel_hi:[0,1,1]
    v_pk_fma_f32 v[136:137], v[30:31], v[136:137], v[84:85] op_sel:[0,0,0] op_sel_hi:[0,1,1]
    v_pk_fma_f32 v[138:139], v[30:31], v[138:139], v[86:87] op_sel:[0,0,0] op_sel_hi:[0,1,1]
    v_pk_mul_f32 v[80:81], v[132:133], v[132:133]
    v_pk_mul_f32 v[82:83], v[134:135], v[134:135]
    v_pk_mul_f32 v[84:85], v[136:137], v[136:137]
    v_pk_mul_f32 v[86:87], v[138:139], v[138:139]
    v_pk_fma_f32 v[80:81], v[80:81], v[68:69], v[68:69] op_sel:[0,1,0] op_sel_hi:[1,1,0]
    v_pk_fma_f32 v[82:83], v[82:83], v[68:69], v[68:69] op_sel:[0,1,0] op_sel_hi:[1,1,0]
    v_pk_fma_f32 v[84:85], v[84:85], v[68:69], v[68:69] op_sel:[0,1,0] op_sel_hi:[1,1,0]
    v_pk_fma_f32 v[86:87], v[86:87], v[68:69], v[68:69] op_sel:[0,1,0] op_sel_hi:[1,1,0]
    v_pk_mul_f32 v[80:81], v[80:81], v[132:133]
    v_pk_mul_f32 v[82:83], v[82:83], v[134:135]
    v_pk_mul_f32 v[84:85], v[84:85], v[136:137]
    v_pk_mul_f32 v[86:87], v[86:87], v[138:139]
    v_exp_f32 v80, v80
    v_exp_f32 v81, v81
    v_exp_f32 v82, v82
    v_exp_f32 v83, v83
    v_exp_f32 v84, v84
    v_exp_f32 v85, v85
    v_exp_f32 v86, v86
    v_exp_f32 v87, v87
    v_pk_add_f32 v[80:81], v[80:81], v[70:71] op_sel_hi:[1,0]
    v_pk_add_f32 v[82:83], v[82:83], v[70:71] op_sel_hi:[1,0]
    v_pk_add_f32 v[84:85], v[84:85], v[70:71] op_sel_hi:[1,0]
    v_pk_add_f32 v[86:87], v[86:87], v[70:71] op_sel_hi:[1,0]
    v_rcp_f32 v80, v80
    v_rcp_f32 v81, v81
    v_rcp_f32 v82, v82
    v_rcp_f32 v83, v83
    v_rcp_f32 v84, v84
    v_rcp_f32 v85, v85
    v_rcp_f32 v86, v86
    v_rcp_f32 v87, v87
    v_pk_mul_f32 v[80:81], v[80:81], v[132:133]
    v_pk_mul_f32 v[82:83], v[82:83], v[134:135]
    v_pk_mul_f32 v[84:85], v[84:85], v[136:137]
    v_pk_mul_f32 v[86:87], v[86:87], v[138:139]
    v_cvt_pk_bf16_f32 v132, v80, v81
    v_cvt_pk_bf16_f32 v133, v82, v83
    v_cvt_pk_bf16_f32 v134, v84, v85
    v_cvt_pk_bf16_f32 v135, v86, v87
    buffer_store_dwordx4 v[132:135], v5, s[24:27], s22 offen offset:2048 sc1
    v_pk_fma_f32 v[80:81], v[46:47], v[168:169], v[72:73] op_sel:[1,0,0] op_sel_hi:[1,1,1] neg_lo:[1,0,0] neg_hi:[1,0,0]
    v_pk_fma_f32 v[82:83], v[46:47], v[170:171], v[74:75] op_sel:[1,0,0] op_sel_hi:[1,1,1] neg_lo:[1,0,0] neg_hi:[1,0,0]
    v_pk_fma_f32 v[84:85], v[46:47], v[172:173], v[76:77] op_sel:[1,0,0] op_sel_hi:[1,1,1] neg_lo:[1,0,0] neg_hi:[1,0,0]
    v_pk_fma_f32 v[86:87], v[46:47], v[174:175], v[78:79] op_sel:[1,0,0] op_sel_hi:[1,1,1] neg_lo:[1,0,0] neg_hi:[1,0,0]
    v_pk_fma_f32 v[148:149], v[30:31], v[148:149], v[80:81] op_sel:[1,0,0] op_sel_hi:[1,1,1]
    v_pk_fma_f32 v[150:151], v[30:31], v[150:151], v[82:83] op_sel:[1,0,0] op_sel_hi:[1,1,1]
    v_pk_fma_f32 v[152:153], v[30:31], v[152:153], v[84:85] op_sel:[1,0,0] op_sel_hi:[1,1,1]
    v_pk_fma_f32 v[154:155], v[30:31], v[154:155], v[86:87] op_sel:[1,0,0] op_sel_hi:[1,1,1]
    v_pk_mul_f32 v[80:81], v[148:149], v[148:149]
    v_pk_mul_f32 v[82:83], v[150:151], v[150:151]
    v_pk_mul_f32 v[84:85], v[152:153], v[152:153]
    v_pk_mul_f32 v[86:87], v[154:155], v[154:155]
    v_pk_fma_f32 v[80:81], v[80:81], v[68:69], v[68:69] op_sel:[0,1,0] op_sel_hi:[1,1,0]
    v_pk_fma_f32 v[82:83], v[82:83], v[68:69], v[68:69] op_sel:[0,1,0] op_sel_hi:[1,1,0]
    v_pk_fma_f32 v[84:85], v[84:85], v[68:69], v[68:69] op_sel:[0,1,0] op_sel_hi:[1,1,0]
    v_pk_fma_f32 v[86:87], v[86:87], v[68:69], v[68:69] op_sel:[0,1,0] op_sel_hi:[1,1,0]
    v_pk_mul_f32 v[80:81], v[80:81], v[148:149]
    v_pk_mul_f32 v[82:83], v[82:83], v[150:151]
    v_pk_mul_f32 v[84:85], v[84:85], v[152:153]
    v_pk_mul_f32 v[86:87], v[86:87], v[154:155]
    v_exp_f32 v80, v80
    v_exp_f32 v81, v81
    v_exp_f32 v82, v82
    v_exp_f32 v83, v83
    v_exp_f32 v84, v84
    v_exp_f32 v85, v85
    v_exp_f32 v86, v86
    v_exp_f32 v87, v87
    v_pk_add_f32 v[80:81], v[80:81], v[70:71] op_sel_hi:[1,0]
    v_pk_add_f32 v[82:83], v[82:83], v[70:71] op_sel_hi:[1,0]
    v_pk_add_f32 v[84:85], v[84:85], v[70:71] op_sel_hi:[1,0]
    v_pk_add_f32 v[86:87], v[86:87], v[70:71] op_sel_hi:[1,0]
    v_rcp_f32 v80, v80
    v_rcp_f32 v81, v81
    v_rcp_f32 v82, v82
    v_rcp_f32 v83, v83
    v_rcp_f32 v84, v84
    v_rcp_f32 v85, v85
    v_rcp_f32 v86, v86
    v_rcp_f32 v87, v87
    v_pk_mul_f32 v[80:81], v[80:81], v[148:149]
    v_pk_mul_f32 v[82:83], v[82:83], v[150:151]
    v_pk_mul_f32 v[84:85], v[84:85], v[152:153]
    v_pk_mul_f32 v[86:87], v[86:87], v[154:155]
    v_cvt_pk_bf16_f32 v148, v80, v81
    v_cvt_pk_bf16_f32 v149, v82, v83
    v_cvt_pk_bf16_f32 v150, v84, v85
    v_cvt_pk_bf16_f32 v151, v86, v87
    buffer_store_dwordx4 v[148:151], v5, s[24:27], s22 offen offset:3072 sc1
L_k1b_skip:
    v_and_b32 v1, 63, v0
    v_mov_b32 v3, s63
    v_lshrrev_b32 v2, 1, v1
    v_and_b32 v4, 1, v1
    v_lshlrev_b32 v2, 8, v2
    v_lshl_add_u32 v2, v4, 2, v2
    s_waitcnt vmcnt(0)
    s_mov_b64 exec, 0xffff
    buffer_store_dword v3, v2, s[24:27], s55 offen sc1
    s_mov_b64 exec, -1
    s_branch L_p2_pq
L_k1_spare:
    v_and_b32 v1, 63, v0
    s_cmp_eq_u32 s53, 1
    s_cbranch_scc1 L_k1_si
    s_and_b32 s40, s2, 6
    s_sub_u32 s41, 12, s40
    s_cmp_lt_u32 s2, 128
    s_cselect_b32 s40, s40, s41
    s_lshr_b32 s41, s2, 6
    s_add_u32 s40, s40, s41
    s_lshl_b32 s40, s40, 1
    s_and_b32 s41, s2, 1
    s_add_u32 s40, s40, s41
    s_lshl_b32 s40, s40, 3
    s_bfe_u32 s41, s2, 0x30003
    s_add_u32 s40, s40, s41
    s_lshl_b32 s40, s40, 2
    s_add_u32 s40, s40, s16
    s_sub_u32 s41, 2048, s40
    s_cmp_eq_u32 s40, 0
    s_cselect_b32 s41, 1024, s41
    v_lshlrev_b32 v240, 4, v1
    s_lshl_b32 s22, s40, 10
    s_lshl_b32 s23, s41, 10
    buffer_load_dwordx4 v[216:219], v240, s[8:11], s22 offen
    buffer_load_dwordx4 v[220:223], v240, s[8:11], s23 offen
    s_waitcnt vmcnt(0)
    v_mov_b32 v236, 0
    buffer_load_dword v236, v236, s[64:67], 0 offen sc1
    s_mov_b32 s42, 0x3f803f80
    v_mov_b32 v242, 0
    v_mov_b32 v243, 0
    v_mov_b32 v244, 0
    v_mov_b32 v245, 0
    v_dot2c_f32_bf16 v242, s42, v216
    v_dot2c_f32_bf16 v244, v216, v216
    v_dot2c_f32_bf16 v243, s42, v220
    v_dot2c_f32_bf16 v245, v220, v220
    v_dot2c_f32_bf16 v242, s42, v217
    v_dot2c_f32_bf16 v244, v217, v217
    v_dot2c_f32_bf16 v243, s42, v221
    v_dot2c_f32_bf16 v245, v221, v221
    v_dot2c_f32_bf16 v242, s42, v218
    v_dot2c_f32_bf16 v244, v218, v218
    v_dot2c_f32_bf16 v243, s42, v222
    v_dot2c_f32_bf16 v245, v222, v222
    v_dot2c_f32_bf16 v242, s42, v219
    v_dot2c_f32_bf16 v244, v219, v219
    v_dot2c_f32_bf16 v243, s42, v223
    v_dot2c_f32_bf16 v245, v223, v223
    v_mov_b32 v249, s41
    v_mov_b32 v248, s40
    v_cmp_gt_u32 vcc, 32, v1
    v_permlane32_swap_b32 v242, v243
    v_permlane32_swap_b32 v244, v245
    v_cndmask_b32 v249, v249, v248, vcc
    v_add_f32 v242, v242, v243
    v_add_f32 v244, v244, v245
    v_lshlrev_b32 v249, 4, v249
    s_nop 0
    v_permlane16_swap_b32 v242, v244
    s_nop 0
    v_add_f32 v242, v242, v244
    s_nop 1
    v_add_f32_dpp v242, v242, v242 row_ror:8 row_mask:0xf bank_mask:0xf
    s_nop 1
    v_add_f32_dpp v242, v242, v242 row_ror:4 row_mask:0xf bank_mask:0xf
    s_nop 1
    v_add_f32_dpp v242, v242, v242 row_ror:2 row_mask:0xf bank_mask:0xf
    s_nop 1
    v_add_f32_dpp v242, v242, v242 row_ror:1 row_mask:0xf bank_mask:0xf
    v_mov_b32 v243, v242
    s_nop 1
    v_permlane16_swap_b32 v242, v243
    s_nop 0
    v_mul_f32 v242, 0x3b000000, v242
    v_mul_f32 v243, 0x3b000000, v243
    v_fma_f32 v243, -v242, v242, v243
    v_max_f32 v243, 0, v243
    v_mov_b32 v245, v243
    v_cvt_pk_bf16_f32 v245, v245, v245
    v_lshlrev_b32 v245, 16, v245
    v_add_f32 v245, 0x3727c5ac, v245
    v_cvt_pk_bf16_f32 v245, v245, v245
    v_lshlrev_b32 v245, 16, v245
    v_sqrt_f32 v245, v245
    s_nop 0
    v_cvt_pk_bf16_f32 v218, v242, v245
    v_lshlrev_b32 v244, 16, v218
    v_and_b32 v245, 0xffff0000, v218
    v_rcp_f32 v245, v245
    v_sub_f32 v246, v242, v244
    v_mul_f32 v246, v246, v245
    v_cvt_pk_bf16_f32 v246, v246, v246
    v_lshlrev_b32 v246, 16, v246
    v_mul_f32 v243, v243, v245
    v_mul_f32 v243, v243, v245
    v_cvt_pk_bf16_f32 v243, v243, v243
    v_lshlrev_b32 v243, 16, v243
    v_add_f32 v243, 0x3727c5ac, v243
    v_cvt_pk_bf16_f32 v243, v243, v243
    v_lshlrev_b32 v243, 16, v243
    v_sqrt_f32 v243, v243
    s_nop 0
    v_cvt_pk_bf16_f32 v243, v243, v243
    v_lshlrev_b32 v243, 16, v243
    v_rcp_f32 v243, v243
    v_fma_f32 v244, v244, v245, v246
    v_mul_f32 v217, v244, v243
    v_mul_f32 v216, v245, v243
L_k1_si:
    s_sub_u32 s30, s2, 240
    s_mov_b32 s88, s6
    s_mov_b32 s89, s7
    s_mov_b32 s90, 1409024
    s_mov_b32 s91, 0x20000
    v_lshrrev_b32 v2, 3, v1
    v_and_b32 v4, 7, v1
    v_lshlrev_b32 v5, 10, v2
    v_lshl_add_u32 v5, v4, 4, v5
    s_lshl_b32 s32, s30, 15
    s_lshl_b32 s23, s54, 7
    s_add_u32 s33, s32, s23
    s_mul_i32 s19, s54, 15360
    v_lshrrev_b32 v6, 1, v1
    v_and_b32 v7, 1, v1
    v_lshlrev_b32 v6, 10, v6
    v_lshl_add_u32 v8, v7, 4, v6
    s_add_u32 s23, s23, 128
    s_cmp_eq_u32 s54, 7
    s_cselect_b32 s23, 512, s23
    s_add_u32 s32, s23, s32
    s_cmp_eq_u32 s53, 0
    s_cselect_b32 s32, 0x40000000, s32
    s_add_u32 m0, s19, 0
    s_add_u32 s22, s33, 0
    buffer_load_dwordx4 v5, s[88:91], s22 offen lds
    s_add_u32 m0, s19, 1024
    s_add_u32 s22, s33, 8192
    buffer_load_dwordx4 v5, s[88:91], s22 offen lds
    s_add_u32 m0, s19, 2048
    s_add_u32 s22, s33, 16384
    buffer_load_dwordx4 v5, s[88:91], s22 offen lds
    s_add_u32 m0, s19, 3072
    s_add_u32 s22, s33, 24576
    buffer_load_dwordx4 v5, s[88:91], s22 offen lds
    s_add_u32 m0, s19, 4096
    s_add_u32 s22, s32, 0
    buffer_load_dwordx4 v8, s[88:91], s22 offen lds
    s_add_u32 m0, s19, 5120
    s_add_u32 s22, s33, 524288
    buffer_load_dwordx4 v5, s[88:91], s22 offen lds
    s_add_u32 m0, s19, 6144
    s_add_u32 s22, s33, 532480
    buffer_load_dwordx4 v5, s[88:91], s22 offen lds
    s_add_u32 m0, s19, 7168
    s_add_u32 s22, s33, 540672
    buffer_load_dwordx4 v5, s[88:91], s22 offen lds
    s_add_u32 m0, s19, 8192
    s_add_u32 s22, s33, 548864
    buffer_load_dwordx4 v5, s[88:91], s22 offen lds
    s_add_u32 m0, s19, 9216
    s_add_u32 s22, s32, 524288
    buffer_load_dwordx4 v8, s[88:91], s22 offen lds
    s_add_u32 m0, s19, 10240
    s_add_u32 s22, s33, 1048576
    buffer_load_dwordx4 v5, s[88:91], s22 offen lds
    s_add_u32 m0, s19, 11264
    s_add_u32 s22, s33, 1056768
    buffer_load_dwordx4 v5, s[88:91], s22 offen lds
    s_add_u32 m0, s19, 12288
    s_add_u32 s22, s33, 1064960
    buffer_load_dwordx4 v5, s[88:91], s22 offen lds
    s_add_u32 m0, s19, 13312
    s_add_u32 s22, s33, 1073152
    buffer_load_dwordx4 v5, s[88:91], s22 offen lds
    s_add_u32 m0, s19, 14336
    s_add_u32 s22, s32, 1048576
    buffer_load_dwordx4 v8, s[88:91], s22 offen lds
    v_and_b32 v7, 15, v1
    v_cmp_eq_u32 s[94:95], 0, v7
    v_lshrrev_b32 v9, 2, v1
    v_and_b32 v7, 3, v1
    v_lshl_add_u32 v7, v7, 3, s19
    v_lshl_add_u32 v158, v9, 7, v7
    v_lshl_add_u32 v159, v9, 5, v7
    v_lshlrev_b32 v155, 4, v1
    v_lshlrev_b32 v157, 9, v1
    s_mul_i32 s22, s53, 7
    s_xor_b32 s32, s54, s22
    s_mul_i32 s22, s32, 86
    s_add_u32 s22, s22, s30
    s_lshl_b32 s22, s22, 12
    s_cmp_eq_u32 s53, 0
    s_cselect_b64 s[94:95], 0, s[94:95]
    s_cselect_b32 s23, 0, 179200
    s_cselect_b32 s85, 1, -1
    s_mul_i32 s86, s85, 176128
    s_lshl_b32 s85, s85, 10
    s_add_u32 s84, s22, s23
    s_add_u32 s84, s84, 8388608
    s_add_u32 s86, s86, s84
    s_add_u32 s87, s86, s85
    s_add_u32 s85, s85, s84
    s_lshl_b32 s22, s32, 5
    s_lshl_b32 s23, s30, 1
    s_add_u32 s22, s22, s23
    s_add_u32 s22, s22, s53
    s_lshl_b32 s22, s22, 2
    s_add_u32 s92, s22, 15859712
    s_cmp_eq_u32 s53, 1
    s_cbranch_scc1 L_k1_sn
    v_mov_b32 v248, s41
    v_mov_b32 v249, s40
    v_cmp_gt_u32 vcc, 32, v1
    s_nop 1
    v_cndmask_b32 v249, v248, v249, vcc
    v_lshlrev_b32 v249, 4, v249
    s_waitcnt vmcnt(15)
    v_readfirstlane_b32 s63, v236
    s_mov_b32 s23, 0x20000
L_tk8:
    s_cmp_lg_u32 s63, 0
    s_cbranch_scc1 L_tk8x
    s_sub_u32 s23, s23, 1
    s_cmp_eq_u32 s23, 0
    s_cbranch_scc1 L_tk8x
    s_sleep 4
    v_mov_b32 v242, 0
    buffer_load_dword v236, v242, s[64:67], 0 offen sc1
    s_waitcnt vmcnt(0)
    v_readfirstlane_b32 s63, v236
    s_branch L_tk8
L_tk8x:
    v_mov_b32 v219, s63
    s_mov_b32 s22, 14745600
    s_mov_b32 exec_lo, 1
    s_mov_b32 exec_hi, 1
    buffer_store_dwordx4 v[216:219], v249, s[24:27], s22 offen sc1
    s_mov_b64 exec, -1
L_k1_sn:
    s_waitcnt vmcnt(10)
    ds_read_b64_tr_b16 v[64:65], v158 offset:0
    ds_read_b64_tr_b16 v[66:67], v158 offset:2048
    ds_read_b64_tr_b16 v[68:69], v158 offset:32
    ds_read_b64_tr_b16 v[70:71], v158 offset:2080
    ds_read_b64_tr_b16 v[72:73], v158 offset:64
    ds_read_b64_tr_b16 v[74:75], v158 offset:2112
    ds_read_b64_tr_b16 v[76:77], v158 offset:96
    ds_read_b64_tr_b16 v[78:79], v158 offset:2144
    ds_read_b64_tr_b16 v[80:81], v159 offset:4096
    ds_read_b64_tr_b16 v[82:83], v159 offset:4608
    v_mov_b32 v156, 0
    buffer_load_dword v156, v156, s[64:67], 0 offen sc1
    s_waitcnt lgkmcnt(6)
    v_cndmask_b32 v64, v64, v68, s[94:95]
    v_cndmask_b32 v65, v65, v69, s[94:95]
    v_cndmask_b32 v66, v66, v70, s[94:95]
    v_cndmask_b32 v67, v67, v71, s[94:95]
    buffer_store_dwordx4 v[64:67], v155, s[24:27], s84 offen sc1
    s_waitcnt lgkmcnt(4)
    v_cndmask_b32 v68, v68, v72, s[94:95]
    v_cndmask_b32 v69, v69, v73, s[94:95]
    v_cndmask_b32 v70, v70, v74, s[94:95]
    v_cndmask_b32 v71, v71, v75, s[94:95]
    buffer_store_dwordx4 v[68:71], v155, s[24:27], s85 offen sc1
    s_waitcnt lgkmcnt(2)
    v_cndmask_b32 v72, v72, v76, s[94:95]
    v_cndmask_b32 v73, v73, v77, s[94:95]
    v_cndmask_b32 v74, v74, v78, s[94:95]
    v_cndmask_b32 v75, v75, v79, s[94:95]
    buffer_store_dwordx4 v[72:75], v155, s[24:27], s86 offen sc1
    s_waitcnt lgkmcnt(0)
    v_cndmask_b32 v76, v76, v80, s[94:95]
    v_cndmask_b32 v77, v77, v81, s[94:95]
    v_cndmask_b32 v78, v78, v82, s[94:95]
    v_cndmask_b32 v79, v79, v83, s[94:95]
    buffer_store_dwordx4 v[76:79], v155, s[24:27], s87 offen sc1
    v_add_u32 v155, 65536, v155
    s_waitcnt vmcnt(10)
    ds_read_b64_tr_b16 v[84:85], v158 offset:5120
    ds_read_b64_tr_b16 v[86:87], v158 offset:7168
    ds_read_b64_tr_b16 v[88:89], v158 offset:5152
    ds_read_b64_tr_b16 v[90:91], v158 offset:7200
    ds_read_b64_tr_b16 v[92:93], v158 offset:5184
    ds_read_b64_tr_b16 v[94:95], v158 offset:7232
    ds_read_b64_tr_b16 v[96:97], v158 offset:5216
    ds_read_b64_tr_b16 v[98:99], v158 offset:7264
    ds_read_b64_tr_b16 v[100:101], v159 offset:9216
    ds_read_b64_tr_b16 v[102:103], v159 offset:9728
    s_waitcnt lgkmcnt(6)
    v_cndmask_b32 v84, v84, v88, s[94:95]
    v_cndmask_b32 v85, v85, v89, s[94:95]
    v_cndmask_b32 v86, v86, v90, s[94:95]
    v_cndmask_b32 v87, v87, v91, s[94:95]
    buffer_store_dwordx4 v[84:87], v155, s[24:27], s84 offen sc1
    s_waitcnt lgkmcnt(4)
    v_cndmask_b32 v88, v88, v92, s[94:95]
    v_cndmask_b32 v89, v89, v93, s[94:95]
    v_cndmask_b32 v90, v90, v94, s[94:95]
    v_cndmask_b32 v91, v91, v95, s[94:95]
    buffer_store_dwordx4 v[88:91], v155, s[24:27], s85 offen sc1
    s_waitcnt lgkmcnt(2)
    v_cndmask_b32 v92, v92, v96, s[94:95]
    v_cndmask_b32 v93, v93, v97, s[94:95]
    v_cndmask_b32 v94, v94, v98, s[94:95]
    v_cndmask_b32 v95, v95, v99, s[94:95]
    buffer_store_dwordx4 v[92:95], v155, s[24:27], s86 offen sc1
    s_waitcnt lgkmcnt(0)
    v_cndmask_b32 v96, v96, v100, s[94:95]
    v_cndmask_b32 v97, v97, v101, s[94:95]
    v_cndmask_b32 v98, v98, v102, s[94:95]
    v_cndmask_b32 v99, v99, v103, s[94:95]
    buffer_store_dwordx4 v[96:99], v155, s[24:27], s87 offen sc1
    v_add_u32 v155, 65536, v155
    s_cmp_ge_u32 s30, 11
    s_cbranch_scc1 L_wf7
    s_waitcnt vmcnt(9)
    ds_read_b64_tr_b16 v[104:105], v158 offset:10240
    ds_read_b64_tr_b16 v[106:107], v158 offset:12288
    ds_read_b64_tr_b16 v[108:109], v158 offset:10272
    ds_read_b64_tr_b16 v[110:111], v158 offset:12320
    ds_read_b64_tr_b16 v[112:113], v158 offset:10304
    ds_read_b64_tr_b16 v[114:115], v158 offset:12352
    ds_read_b64_tr_b16 v[116:117], v158 offset:10336
    ds_read_b64_tr_b16 v[118:119], v158 offset:12384
    ds_read_b64_tr_b16 v[120:121], v159 offset:14336
    ds_read_b64_tr_b16 v[122:123], v159 offset:14848
    s_waitcnt lgkmcnt(6)
    v_cndmask_b32 v104, v104, v108, s[94:95]
    v_cndmask_b32 v105, v105, v109, s[94:95]
    v_cndmask_b32 v106, v106, v110, s[94:95]
    v_cndmask_b32 v107, v107, v111, s[94:95]
    buffer_store_dwordx4 v[104:107], v155, s[24:27], s84 offen sc1
    s_waitcnt lgkmcnt(4)
    v_cndmask_b32 v108, v108, v112, s[94:95]
    v_cndmask_b32 v109, v109, v113, s[94:95]
    v_cndmask_b32 v110, v110, v114, s[94:95]
    v_cndmask_b32 v111, v111, v115, s[94:95]
    buffer_store_dwordx4 v[108:111], v155, s[24:27], s85 offen sc1
    s_waitcnt lgkmcnt(2)
    v_cndmask_b32 v112, v112, v116, s[94:95]
    v_cndmask_b32 v113, v113, v117, s[94:95]
    v_cndmask_b32 v114, v114, v118, s[94:95]
    v_cndmask_b32 v115, v115, v119, s[94:95]
    buffer_store_dwordx4 v[112:115], v155, s[24:27], s86 offen sc1
    s_waitcnt lgkmcnt(0)
    v_cndmask_b32 v116, v116, v120, s[94:95]
    v_cndmask_b32 v117, v117, v121, s[94:95]
    v_cndmask_b32 v118, v118, v122, s[94:95]
    v_cndmask_b32 v119, v119, v123, s[94:95]
    buffer_store_dwordx4 v[116:119], v155, s[24:27], s87 offen sc1
L_wf7:
    s_waitcnt vmcnt(0)
    v_readfirstlane_b32 s63, v156
    s_mov_b32 s23, 0x20000
L_tk9:
    s_cmp_lg_u32 s63, 0
    s_cbranch_scc1 L_tk9x
    s_sub_u32 s23, s23, 1
    s_cmp_eq_u32 s23, 0
    s_cbranch_scc1 L_tk9x
    s_sleep 4
    v_mov_b32 v158, 0
    buffer_load_dword v156, v158, s[64:67], 0 offen sc1
    s_waitcnt vmcnt(0)
    v_readfirstlane_b32 s63, v156
    s_branch L_tk9
L_tk9x:
    s_mov_b64 exec, 0xff
    buffer_store_dword v156, v157, s[24:27], s92 offen sc1
    s_mov_b64 exec, -1
    s_barrier
L_k1_sfl:
    s_cmp_eq_u32 s53, 0
    s_cbranch_scc0 L_k1_sz
    s_and_b32 s22, s2, 6
    s_sub_u32 s23, 12, s22
    s_cmp_lt_u32 s2, 128
    s_cselect_b32 s22, s22, s23
    s_lshr_b32 s23, s2, 6
    s_add_u32 s22, s22, s23
    s_lshl_b32 s22, s22, 6
    s_and_b32 s23, s2, 1
    s_add_u32 s22, s22, s23
    v_and_b32 v8, 15, v1
    v_lshl_add_u32 v8, v8, 1, s22
    v_lshlrev_b32 v42, 12, v8
    v_add_u32 v43, 131072, v42
    v_lshrrev_b32 v8, 4, v1
    s_lshr_b32 s22, s16, 1
    s_lshl_b32 s22, s22, 8
    v_lshl_add_u32 v8, v8, 3, s22
    v_mul_lo_u32 v40, v8, v42
    v_mul_lo_u32 v41, v8, v43
    s_and_b32 s22, s16, 1
    s_lshl_b32 s22, s22, 21
    v_add_u32 v40, s22, v40
    v_add_u32 v41, s22, v41
    v_mov_b32 v44, 1.0
    v_mul_u32_u24 v45, 24, v42
    v_mul_u32_u24 v46, 24, v43
    s_mov_b32 s59, 0x7ff000
    v_and_or_b32 v32, v40, s59, v44
    v_add_u32 v40, v40, v42
    v_and_or_b32 v33, v40, s59, v44
    v_add_u32 v40, v40, v42
    v_and_or_b32 v34, v40, s59, v44
    v_add_u32 v40, v40, v42
    v_and_or_b32 v35, v40, s59, v44
    v_add_u32 v40, v40, v42
    v_and_or_b32 v36, v40, s59, v44
    v_add_u32 v40, v40, v42
    v_and_or_b32 v37, v40, s59, v44
    v_add_u32 v40, v40, v42
    v_and_or_b32 v38, v40, s59, v44
    v_add_u32 v40, v40, v42
    v_and_or_b32 v39, v40, s59, v44
    v_add_u32 v40, v40, v42
    v_cos_f32 v32, v32
    v_cos_f32 v33, v33
    v_cos_f32 v34, v34
    v_cos_f32 v35, v35
    v_cos_f32 v36, v36
    v_cos_f32 v37, v37
    v_cos_f32 v38, v38
    v_cos_f32 v39, v39
    v_add_u32 v40, v40, v45
    v_cvt_pk_bf16_f32 v192, v32, v33
    v_cvt_pk_bf16_f32 v193, v34, v35
    v_cvt_pk_bf16_f32 v194, v36, v37
    v_cvt_pk_bf16_f32 v195, v38, v39
    v_and_or_b32 v32, v41, s59, v44
    v_add_u32 v41, v41, v43
    v_and_or_b32 v33, v41, s59, v44
    v_add_u32 v41, v41, v43
    v_and_or_b32 v34, v41, s59, v44
    v_add_u32 v41, v41, v43
    v_and_or_b32 v35, v41, s59, v44
    v_add_u32 v41, v41, v43
    v_and_or_b32 v36, v41, s59, v44
    v_add_u32 v41, v41, v43
    v_and_or_b32 v37, v41, s59, v44
    v_add_u32 v41, v41, v43
    v_and_or_b32 v38, v41, s59, v44
    v_add_u32 v41, v41, v43
    v_and_or_b32 v39, v41, s59, v44
    v_add_u32 v41, v41, v43
    v_cos_f32 v32, v32
    v_cos_f32 v33, v33
    v_cos_f32 v34, v34
    v_cos_f32 v35, v35
    v_cos_f32 v36, v36
    v_cos_f32 v37, v37
    v_cos_f32 v38, v38
    v_cos_f32 v39, v39
    v_add_u32 v41, v41, v46
    v_cvt_pk_bf16_f32 v196, v32, v33
    v_cvt_pk_bf16_f32 v197, v34, v35
    v_cvt_pk_bf16_f32 v198, v36, v37
    v_cvt_pk_bf16_f32 v199, v38, v39
    v_and_or_b32 v32, v40, s59, v44
    v_add_u32 v40, v40, v42
    v_and_or_b32 v33, v40, s59, v44
    v_add_u32 v40, v40, v42
    v_and_or_b32 v34, v40, s59, v44
    v_add_u32 v40, v40, v42
    v_and_or_b32 v35, v40, s59, v44
    v_add_u32 v40, v40, v42
    v_and_or_b32 v36, v40, s59, v44
    v_add_u32 v40, v40, v42
    v_and_or_b32 v37, v40, s59, v44
    v_add_u32 v40, v40, v42
    v_and_or_b32 v38, v40, s59, v44
    v_add_u32 v40, v40, v42
    v_and_or_b32 v39, v40, s59, v44
    v_add_u32 v40, v40, v42
    v_cos_f32 v32, v32
    v_cos_f32 v33, v33
    v_cos_f32 v34, v34
    v_cos_f32 v35, v35
    v_cos_f32 v36, v36
    v_cos_f32 v37, v37
    v_cos_f32 v38, v38
    v_cos_f32 v39, v39
    v_add_u32 v40, v40, v45
    v_cvt_pk_bf16_f32 v200, v32, v33
    v_cvt_pk_bf16_f32 v201, v34, v35
    v_cvt_pk_bf16_f32 v202, v36, v37
    v_cvt_pk_bf16_f32 v203, v38, v39
    v_and_or_b32 v32, v41, s59, v44
    v_add_u32 v41, v41, v43
    v_and_or_b32 v33, v41, s59, v44
    v_add_u32 v41, v41, v43
    v_and_or_b32 v34, v41, s59, v44
    v_add_u32 v41, v41, v43
    v_and_or_b32 v35, v41, s59, v44
    v_add_u32 v41, v41, v43
    v_and_or_b32 v36, v41, s59, v44
    v_add_u32 v41, v41, v43
    v_and_or_b32 v37, v41, s59, v44
    v_add_u32 v41, v41, v43
    v_and_or_b32 v38, v41, s59, v44
    v_add_u32 v41, v41, v43
    v_and_or_b32 v39, v41, s59, v44
    v_add_u32 v41, v41, v43
    v_cos_f32 v32, v32
    v_cos_f32 v33, v33
    v_cos_f32 v34, v34
    v_cos_f32 v35, v35
    v_cos_f32 v36, v36
    v_cos_f32 v37, v37
    v_cos_f32 v38, v38
    v_cos_f32 v39, v39
    v_add_u32 v41, v41, v46
    v_cvt_pk_bf16_f32 v204, v32, v33
    v_cvt_pk_bf16_f32 v205, v34, v35
    v_cvt_pk_bf16_f32 v206, v36, v37
    v_cvt_pk_bf16_f32 v207, v38, v39
    v_and_or_b32 v32, v40, s59, v44
    v_add_u32 v40, v40, v42
    v_and_or_b32 v33, v40, s59, v44
    v_add_u32 v40, v40, v42
    v_and_or_b32 v34, v40, s59, v44
    v_add_u32 v40, v40, v42
    v_and_or_b32 v35, v40, s59, v44
    v_add_u32 v40, v40, v42
    v_and_or_b32 v36, v40, s59, v44
    v_add_u32 v40, v40, v42
    v_and_or_b32 v37, v40, s59, v44
    v_add_u32 v40, v40, v42
    v_and_or_b32 v38, v40, s59, v44
    v_add_u32 v40, v40, v42
    v_and_or_b32 v39, v40, s59, v44
    v_add_u32 v40, v40, v42
    v_cos_f32 v32, v32
    v_cos_f32 v33, v33
    v_cos_f32 v34, v34
    v_cos_f32 v35, v35
    v_cos_f32 v36, v36
    v_cos_f32 v37, v37
    v_cos_f32 v38, v38
    v_cos_f32 v39, v39
    v_add_u32 v40, v40, v45
    v_cvt_pk_bf16_f32 v208, v32, v33
    v_cvt_pk_bf16_f32 v209, v34, v35
    v_cvt_pk_bf16_f32 v210, v36, v37
    v_cvt_pk_bf16_f32 v211, v38, v39
    v_and_or_b32 v32, v41, s59, v44
    v_add_u32 v41, v41, v43
    v_and_or_b32 v33, v41, s59, v44
    v_add_u32 v41, v41, v43
    v_and_or_b32 v34, v41, s59, v44
    v_add_u32 v41, v41, v43
    v_and_or_b32 v35, v41, s59, v44
    v_add_u32 v41, v41, v43
    v_and_or_b32 v36, v41, s59, v44
    v_add_u32 v41, v41, v43
    v_and_or_b32 v37, v41, s59, v44
    v_add_u32 v41, v41, v43
    v_and_or_b32 v38, v41, s59, v44
    v_add_u32 v41, v41, v43
    v_and_or_b32 v39, v41, s59, v44
    v_add_u32 v41, v41, v43
    v_cos_f32 v32, v32
    v_cos_f32 v33, v33
    v_cos_f32 v34, v34
    v_cos_f32 v35, v35
    v_cos_f32 v36, v36
    v_cos_f32 v37, v37
    v_cos_f32 v38, v38
    v_cos_f32 v39, v39
    v_add_u32 v41, v41, v46
    v_cvt_pk_bf16_f32 v212, v32, v33
    v_cvt_pk_bf16_f32 v213, v34, v35
    v_cvt_pk_bf16_f32 v214, v36, v37
    v_cvt_pk_bf16_f32 v215, v38, v39
    v_and_or_b32 v32, v40, s59, v44
    v_add_u32 v40, v40, v42
    v_and_or_b32 v33, v40, s59, v44
    v_add_u32 v40, v40, v42
    v_and_or_b32 v34, v40, s59, v44
    v_add_u32 v40, v40, v42
    v_and_or_b32 v35, v40, s59, v44
    v_add_u32 v40, v40, v42
    v_and_or_b32 v36, v40, s59, v44
    v_add_u32 v40, v40, v42
    v_and_or_b32 v37, v40, s59, v44
    v_add_u32 v40, v40, v42
    v_and_or_b32 v38, v40, s59, v44
    v_add_u32 v40, v40, v42
    v_and_or_b32 v39, v40, s59, v44
    v_add_u32 v40, v40, v42
    v_cos_f32 v32, v32
    v_cos_f32 v33, v33
    v_cos_f32 v34, v34
    v_cos_f32 v35, v35
    v_cos_f32 v36, v36
    v_cos_f32 v37, v37
    v_cos_f32 v38, v38
    v_cos_f32 v39, v39
    v_add_u32 v40, v40, v45
    v_cvt_pk_bf16_f32 v216, v32, v33
    v_cvt_pk_bf16_f32 v217, v34, v35
    v_cvt_pk_bf16_f32 v218, v36, v37
    v_cvt_pk_bf16_f32 v219, v38, v39
    v_and_or_b32 v32, v41, s59, v44
    v_add_u32 v41, v41, v43
    v_and_or_b32 v33, v41, s59, v44
    v_add_u32 v41, v41, v43
    v_and_or_b32 v34, v41, s59, v44
    v_add_u32 v41, v41, v43
    v_and_or_b32 v35, v41, s59, v44
    v_add_u32 v41, v41, v43
    v_and_or_b32 v36, v41, s59, v44
    v_add_u32 v41, v41, v43
    v_and_or_b32 v37, v41, s59, v44
    v_add_u32 v41, v41, v43
    v_and_or_b32 v38, v41, s59, v44
    v_add_u32 v41, v41, v43
    v_and_or_b32 v39, v41, s59, v44
    v_add_u32 v41, v41, v43
    v_cos_f32 v32, v32
    v_cos_f32 v33, v33
    v_cos_f32 v34, v34
    v_cos_f32 v35, v35
    v_cos_f32 v36, v36
    v_cos_f32 v37, v37
    v_cos_f32 v38, v38
    v_cos_f32 v39, v39
    v_add_u32 v41, v41, v46
    v_cvt_pk_bf16_f32 v220, v32, v33
    v_cvt_pk_bf16_f32 v221, v34, v35
    v_cvt_pk_bf16_f32 v222, v36, v37
    v_cvt_pk_bf16_f32 v223, v38, v39
    v_and_or_b32 v32, v40, s59, v44
    v_add_u32 v40, v40, v42
    v_and_or_b32 v33, v40, s59, v44
    v_add_u32 v40, v40, v42
    v_and_or_b32 v34, v40, s59, v44
    v_add_u32 v40, v40, v42
    v_and_or_b32 v35, v40, s59, v44
    v_add_u32 v40, v40, v42
    v_and_or_b32 v36, v40, s59, v44
    v_add_u32 v40, v40, v42
    v_and_or_b32 v37, v40, s59, v44
    v_add_u32 v40, v40, v42
    v_and_or_b32 v38, v40, s59, v44
    v_add_u32 v40, v40, v42
    v_and_or_b32 v39, v40, s59, v44
    v_add_u32 v40, v40, v42
    v_cos_f32 v32, v32
    v_cos_f32 v33, v33
    v_cos_f32 v34, v34
    v_cos_f32 v35, v35
    v_cos_f32 v36, v36
    v_cos_f32 v37, v37
    v_cos_f32 v38, v38
    v_cos_f32 v39, v39
    v_add_u32 v40, v40, v45
    v_cvt_pk_bf16_f32 v224, v32, v33
    v_cvt_pk_bf16_f32 v225, v34, v35
    v_cvt_pk_bf16_f32 v226, v36, v37
    v_cvt_pk_bf16_f32 v227, v38, v39
    v_and_or_b32 v32, v41, s59, v44
    v_add_u32 v41, v41, v43
    v_and_or_b32 v33, v41, s59, v44
    v_add_u32 v41, v41, v43
    v_and_or_b32 v34, v41, s59, v44
    v_add_u32 v41, v41, v43
    v_and_or_b32 v35, v41, s59, v44
    v_add_u32 v41, v41, v43
    v_and_or_b32 v36, v41, s59, v44
    v_add_u32 v41, v41, v43
    v_and_or_b32 v37, v41, s59, v44
    v_add_u32 v41, v41, v43
    v_and_or_b32 v38, v41, s59, v44
    v_add_u32 v41, v41, v43
    v_and_or_b32 v39, v41, s59, v44
    v_add_u32 v41, v41, v43
    v_cos_f32 v32, v32
    v_cos_f32 v33, v33
    v_cos_f32 v34, v34
    v_cos_f32 v35, v35
    v_cos_f32 v36, v36
    v_cos_f32 v37, v37
    v_cos_f32 v38, v38
    v_cos_f32 v39, v39
    v_add_u32 v41, v41, v46
    v_cvt_pk_bf16_f32 v228, v32, v33
    v_cvt_pk_bf16_f32 v229, v34, v35
    v_cvt_pk_bf16_f32 v230, v36, v37
    v_cvt_pk_bf16_f32 v231, v38, v39
    v_and_or_b32 v32, v40, s59, v44
    v_add_u32 v40, v40, v42
    v_and_or_b32 v33, v40, s59, v44
    v_add_u32 v40, v40, v42
    v_and_or_b32 v34, v40, s59, v44
    v_add_u32 v40, v40, v42
    v_and_or_b32 v35, v40, s59, v44
    v_add_u32 v40, v40, v42
    v_and_or_b32 v36, v40, s59, v44
    v_add_u32 v40, v40, v42
    v_and_or_b32 v37, v40, s59, v44
    v_add_u32 v40, v40, v42
    v_and_or_b32 v38, v40, s59, v44
    v_add_u32 v40, v40, v42
    v_and_or_b32 v39, v40, s59, v44
    v_add_u32 v40, v40, v42
    v_cos_f32 v32, v32
    v_cos_f32 v33, v33
    v_cos_f32 v34, v34
    v_cos_f32 v35, v35
    v_cos_f32 v36, v36
    v_cos_f32 v37, v37
    v_cos_f32 v38, v38
    v_cos_f32 v39, v39
    v_add_u32 v40, v40, v45
    v_cvt_pk_bf16_f32 v232, v32, v33
    v_cvt_pk_bf16_f32 v233, v34, v35
    v_cvt_pk_bf16_f32 v234, v36, v37
    v_cvt_pk_bf16_f32 v235, v38, v39
    v_and_or_b32 v32, v41, s59, v44
    v_add_u32 v41, v41, v43
    v_and_or_b32 v33, v41, s59, v44
    v_add_u32 v41, v41, v43
    v_and_or_b32 v34, v41, s59, v44
    v_add_u32 v41, v41, v43
    v_and_or_b32 v35, v41, s59, v44
    v_add_u32 v41, v41, v43
    v_and_or_b32 v36, v41, s59, v44
    v_add_u32 v41, v41, v43
    v_and_or_b32 v37, v41, s59, v44
    v_add_u32 v41, v41, v43
    v_and_or_b32 v38, v41, s59, v44
    v_add_u32 v41, v41, v43
    v_and_or_b32 v39, v41, s59, v44
    v_add_u32 v41, v41, v43
    v_cos_f32 v32, v32
    v_cos_f32 v33, v33
    v_cos_f32 v34, v34
    v_cos_f32 v35, v35
    v_cos_f32 v36, v36
    v_cos_f32 v37, v37
    v_cos_f32 v38, v38
    v_cos_f32 v39, v39
    v_add_u32 v41, v41, v46
    v_cvt_pk_bf16_f32 v236, v32, v33
    v_cvt_pk_bf16_f32 v237, v34, v35
    v_cvt_pk_bf16_f32 v238, v36, v37
    v_cvt_pk_bf16_f32 v239, v38, v39
    v_and_or_b32 v32, v40, s59, v44
    v_add_u32 v40, v40, v42
    v_and_or_b32 v33, v40, s59, v44
    v_add_u32 v40, v40, v42
    v_and_or_b32 v34, v40, s59, v44
    v_add_u32 v40, v40, v42
    v_and_or_b32 v35, v40, s59, v44
    v_add_u32 v40, v40, v42
    v_and_or_b32 v36, v40, s59, v44
    v_add_u32 v40, v40, v42
    v_and_or_b32 v37, v40, s59, v44
    v_add_u32 v40, v40, v42
    v_and_or_b32 v38, v40, s59, v44
    v_add_u32 v40, v40, v42
    v_and_or_b32 v39, v40, s59, v44
    v_add_u32 v40, v40, v42
    v_cos_f32 v32, v32
    v_cos_f32 v33, v33
    v_cos_f32 v34, v34
    v_cos_f32 v35, v35
    v_cos_f32 v36, v36
    v_cos_f32 v37, v37
    v_cos_f32 v38, v38
    v_cos_f32 v39, v39
    v_add_u32 v40, v40, v45
    v_cvt_pk_bf16_f32 v240, v32, v33
    v_cvt_pk_bf16_f32 v241, v34, v35
    v_cvt_pk_bf16_f32 v242, v36, v37
    v_cvt_pk_bf16_f32 v243, v38, v39
    v_and_or_b32 v32, v41, s59, v44
    v_add_u32 v41, v41, v43
    v_and_or_b32 v33, v41, s59, v44
    v_add_u32 v41, v41, v43
    v_and_or_b32 v34, v41, s59, v44
    v_add_u32 v41, v41, v43
    v_and_or_b32 v35, v41, s59, v44
    v_add_u32 v41, v41, v43
    v_and_or_b32 v36, v41, s59, v44
    v_add_u32 v41, v41, v43
    v_and_or_b32 v37, v41, s59, v44
    v_add_u32 v41, v41, v43
    v_and_or_b32 v38, v41, s59, v44
    v_add_u32 v41, v41, v43
    v_and_or_b32 v39, v41, s59, v44
    v_add_u32 v41, v41, v43
    v_cos_f32 v32, v32
    v_cos_f32 v33, v33
    v_cos_f32 v34, v34
    v_cos_f32 v35, v35
    v_cos_f32 v36, v36
    v_cos_f32 v37, v37
    v_cos_f32 v38, v38
    v_cos_f32 v39, v39
    v_add_u32 v41, v41, v46
    v_cvt_pk_bf16_f32 v244, v32, v33
    v_cvt_pk_bf16_f32 v245, v34, v35
    v_cvt_pk_bf16_f32 v246, v36, v37
    v_cvt_pk_bf16_f32 v247, v38, v39
    v_and_or_b32 v32, v40, s59, v44
    v_add_u32 v40, v40, v42
    v_and_or_b32 v33, v40, s59, v44
    v_add_u32 v40, v40, v42
    v_and_or_b32 v34, v40, s59, v44
    v_add_u32 v40, v40, v42
    v_and_or_b32 v35, v40, s59, v44
    v_add_u32 v40, v40, v42
    v_and_or_b32 v36, v40, s59, v44
    v_add_u32 v40, v40, v42
    v_and_or_b32 v37, v40, s59, v44
    v_add_u32 v40, v40, v42
    v_and_or_b32 v38, v40, s59, v44
    v_add_u32 v40, v40, v42
    v_and_or_b32 v39, v40, s59, v44
    v_add_u32 v40, v40, v42
    v_cos_f32 v32, v32
    v_cos_f32 v33, v33
    v_cos_f32 v34, v34
    v_cos_f32 v35, v35
    v_cos_f32 v36, v36
    v_cos_f32 v37, v37
    v_cos_f32 v38, v38
    v_cos_f32 v39, v39
    s_nop 0
    v_cvt_pk_bf16_f32 v248, v32, v33
    v_cvt_pk_bf16_f32 v249, v34, v35
    v_cvt_pk_bf16_f32 v250, v36, v37
    v_cvt_pk_bf16_f32 v251, v38, v39
    v_and_or_b32 v32, v41, s59, v44
    v_add_u32 v41, v41, v43
    v_and_or_b32 v33, v41, s59, v44
    v_add_u32 v41, v41, v43
    v_and_or_b32 v34, v41, s59, v44
    v_add_u32 v41, v41, v43
    v_and_or_b32 v35, v41, s59, v44
    v_add_u32 v41, v41, v43
    v_and_or_b32 v36, v41, s59, v44
    v_add_u32 v41, v41, v43
    v_and_or_b32 v37, v41, s59, v44
    v_add_u32 v41, v41, v43
    v_and_or_b32 v38, v41, s59, v44
    v_add_u32 v41, v41, v43
    v_and_or_b32 v39, v41, s59, v44
    v_add_u32 v41, v41, v43
    v_cos_f32 v32, v32
    v_cos_f32 v33, v33
    v_cos_f32 v34, v34
    v_cos_f32 v35, v35
    v_cos_f32 v36, v36
    v_cos_f32 v37, v37
    v_cos_f32 v38, v38
    v_cos_f32 v39, v39
    s_nop 0
    v_cvt_pk_bf16_f32 v252, v32, v33
    v_cvt_pk_bf16_f32 v253, v34, v35
    v_cvt_pk_bf16_f32 v254, v36, v37
    v_cvt_pk_bf16_f32 v255, v38, v39
    s_branch L_p2_pq
L_k1_sz:
    s_branch L_p2_z
L_p2_z:
    s_setprio 1
    s_and_b32 s22, s2, 7
    s_lshl_b32 s22, s22, 2
    s_bfe_u32 s23, s2, 0x20004
    s_add_u32 s22, s22, s23
    s_lshl_b32 s22, s22, 7
    s_add_u32 s22, s22, 15859712
    v_and_b32 v5, 31, v1
    v_lshl_add_u32 v5, v5, 2, s22
    buffer_load_dword v7, v5, s[24:27], 0 offen sc1
    s_load_dwordx2 s[6:7], s[0:1], 0
    s_load_dwordx4 s[44:47], s[0:1], 72
    s_mov_b32 s17, s54
    v_and_b32 v1, 63, v0
    v_lshlrev_b32 v2, 4, v1
    s_and_b32 s28, s2, 7
    s_lshr_b32 s31, s2, 3
    s_and_b32 s30, s31, 7
    s_and_b32 s29, s2, 6
    s_sub_u32 s22, 12, s29
    s_cmp_lt_u32 s2, 128
    s_cselect_b32 s29, s29, s22
    s_lshr_b32 s22, s2, 6
    s_add_u32 s29, s29, s22
    s_and_b32 s28, s28, 1
    s_lshr_b32 s18, s17, 2
    s_lshl_b32 s19, s28, 4
    s_add_u32 s19, s19, s29
    s_mov_b32 s8, s4
    s_mov_b32 s9, s5
    s_mov_b32 s10, 67108864
    s_mov_b32 s11, 0x20000
    s_lshl_b32 s61, s16, 2
    s_add_u32 s61, s61, 162576
    s_waitcnt lgkmcnt(0)
    s_mul_i32 s48, s19, 176128
    s_mul_i32 s49, s30, 176128
    s_add_u32 s49, s49, 8388608
    s_mul_i32 s58, s16, 45056
    s_add_u32 s48, s48, s58
    s_add_u32 s49, s49, s58
    s_mov_b64 exec, -1
    s_mov_b32 s23, 0x10000
    s_branch L_pw_t
L_pw_p:
    buffer_load_dword v7, v5, s[8:11], 0 offen sc1
L_pw_t:
    s_sub_u32 s23, s23, 1
    s_waitcnt vmcnt(0)
    v_cmp_ne_u32 vcc, s63, v7
    s_cbranch_vccz L_pw_q
    s_cmp_eq_u32 s23, 0
    s_cbranch_scc1 L_pw_q
    s_sleep 4
    s_branch L_pw_p
L_pw_q:
    s_mov_b64 exec, -1
    s_add_u32 s57, s49, 0
    buffer_load_dwordx4 v[16:19], v2, s[8:11], s57 offen offset:0 sc1
    buffer_load_dwordx4 v[20:23], v2, s[8:11], s57 offen offset:1024 sc1
    buffer_load_dwordx4 v[24:27], v2, s[8:11], s57 offen offset:2048 sc1
    buffer_load_dwordx4 v[28:31], v2, s[8:11], s57 offen offset:3072 sc1
    s_add_u32 s57, s49, 4096
    buffer_load_dwordx4 v[32:35], v2, s[8:11], s57 offen offset:0 sc1
    buffer_load_dwordx4 v[36:39], v2, s[8:11], s57 offen offset:1024 sc1
    buffer_load_dwordx4 v[40:43], v2, s[8:11], s57 offen offset:2048 sc1
    buffer_load_dwordx4 v[44:47], v2, s[8:11], s57 offen offset:3072 sc1
    s_add_u32 s57, s49, 8192
    buffer_load_dwordx4 v[48:51], v2, s[8:11], s57 offen offset:0 sc1
    buffer_load_dwordx4 v[52:55], v2, s[8:11], s57 offen offset:1024 sc1
    buffer_load_dwordx4 v[56:59], v2, s[8:11], s57 offen offset:2048 sc1
    buffer_load_dwordx4 v[60:63], v2, s[8:11], s57 offen offset:3072 sc1
    s_lshl_b32 s41, s16, 15
    s_add_u32 m0, s41, 0
    s_add_u32 s42, s49, 12288
    buffer_load_dwordx4 v2, s[8:11], s42 offen offset:0 sc1 lds
    buffer_load_dwordx4 v2, s[8:11], s42 offen offset:1024 sc1 lds
    buffer_load_dwordx4 v2, s[8:11], s42 offen offset:2048 sc1 lds
    buffer_load_dwordx4 v2, s[8:11], s42 offen offset:3072 sc1 lds
    s_add_u32 m0, s41, 4096
    s_add_u32 s42, s49, 16384
    buffer_load_dwordx4 v2, s[8:11], s42 offen offset:0 sc1 lds
    buffer_load_dwordx4 v2, s[8:11], s42 offen offset:1024 sc1 lds
    buffer_load_dwordx4 v2, s[8:11], s42 offen offset:2048 sc1 lds
    buffer_load_dwordx4 v2, s[8:11], s42 offen offset:3072 sc1 lds
    s_add_u32 m0, s41, 8192
    s_add_u32 s42, s49, 20480
    buffer_load_dwordx4 v2, s[8:11], s42 offen offset:0 sc1 lds
    buffer_load_dwordx4 v2, s[8:11], s42 offen offset:1024 sc1 lds
    buffer_load_dwordx4 v2, s[8:11], s42 offen offset:2048 sc1 lds
    buffer_load_dwordx4 v2, s[8:11], s42 offen offset:3072 sc1 lds
    s_add_u32 m0, s41, 12288
    s_add_u32 s42, s49, 24576
    buffer_load_dwordx4 v2, s[8:11], s42 offen offset:0 sc1 lds
    buffer_load_dwordx4 v2, s[8:11], s42 offen offset:1024 sc1 lds
    buffer_load_dwordx4 v2, s[8:11], s42 offen offset:2048 sc1 lds
    buffer_load_dwordx4 v2, s[8:11], s42 offen offset:3072 sc1 lds
    s_add_u32 m0, s41, 16384
    s_add_u32 s42, s49, 28672
    buffer_load_dwordx4 v2, s[8:11], s42 offen offset:0 sc1 lds
    buffer_load_dwordx4 v2, s[8:11], s42 offen offset:1024 sc1 lds
    buffer_load_dwordx4 v2, s[8:11], s42 offen offset:2048 sc1 lds
    buffer_load_dwordx4 v2, s[8:11], s42 offen offset:3072 sc1 lds
    s_add_u32 m0, s41, 20480
    s_add_u32 s42, s49, 32768
    buffer_load_dwordx4 v2, s[8:11], s42 offen offset:0 sc1 lds
    buffer_load_dwordx4 v2, s[8:11], s42 offen offset:1024 sc1 lds
    buffer_load_dwordx4 v2, s[8:11], s42 offen offset:2048 sc1 lds
    buffer_load_dwordx4 v2, s[8:11], s42 offen offset:3072 sc1 lds
    s_add_u32 m0, s41, 24576
    s_add_u32 s42, s49, 36864
    buffer_load_dwordx4 v2, s[8:11], s42 offen offset:0 sc1 lds
    buffer_load_dwordx4 v2, s[8:11], s42 offen offset:1024 sc1 lds
    buffer_load_dwordx4 v2, s[8:11], s42 offen offset:2048 sc1 lds
    buffer_load_dwordx4 v2, s[8:11], s42 offen offset:3072 sc1 lds
    s_cmp_eq_u32 s16, 3
    s_cbranch_scc1 L_p2_w7
    s_add_u32 m0, s41, 28672
    s_add_u32 s42, s49, 40960
    buffer_load_dwordx4 v2, s[8:11], s42 offen offset:0 sc1 lds
    buffer_load_dwordx4 v2, s[8:11], s42 offen offset:1024 sc1 lds
    buffer_load_dwordx4 v2, s[8:11], s42 offen offset:2048 sc1 lds
    buffer_load_dwordx4 v2, s[8:11], s42 offen offset:3072 sc1 lds
L_p2_w7:
    v_mov_b32 v160, 0
    v_mov_b32 v161, 0
    v_mov_b32 v162, 0
    v_mov_b32 v163, 0
    v_mov_b32 v164, 0
    v_mov_b32 v165, 0
    v_mov_b32 v166, 0
    v_mov_b32 v167, 0
    v_mov_b32 v168, 0
    v_mov_b32 v169, 0
    v_mov_b32 v170, 0
    v_mov_b32 v171, 0
    v_mov_b32 v172, 0
    v_mov_b32 v173, 0
    v_mov_b32 v174, 0
    v_mov_b32 v175, 0
    v_mov_b32 v176, 0
    v_mov_b32 v177, 0
    v_mov_b32 v178, 0
    v_mov_b32 v179, 0
    v_mov_b32 v180, 0
    v_mov_b32 v181, 0
    v_mov_b32 v182, 0
    v_mov_b32 v183, 0
    v_mov_b32 v184, 0
    v_mov_b32 v185, 0
    v_mov_b32 v186, 0
    v_mov_b32 v187, 0
    v_mov_b32 v188, 0
    v_mov_b32 v189, 0
    v_mov_b32 v190, 0
    v_mov_b32 v191, 0
    v_mov_b32 v192, 0
    v_mov_b32 v193, 0
    v_mov_b32 v194, 0
    v_mov_b32 v195, 0
    v_mov_b32 v196, 0
    v_mov_b32 v197, 0
    v_mov_b32 v198, 0
    v_mov_b32 v199, 0
    v_mov_b32 v200, 0
    v_mov_b32 v201, 0
    v_mov_b32 v202, 0
    v_mov_b32 v203, 0
    v_mov_b32 v204, 0
    v_mov_b32 v205, 0
    v_mov_b32 v206, 0
    v_mov_b32 v207, 0
    v_mov_b32 v208, 0
    v_mov_b32 v209, 0
    v_mov_b32 v210, 0
    v_mov_b32 v211, 0
    v_mov_b32 v212, 0
    v_mov_b32 v213, 0
    v_mov_b32 v214, 0
    v_mov_b32 v215, 0
    v_mov_b32 v216, 0
    v_mov_b32 v217, 0
    v_mov_b32 v218, 0
    v_mov_b32 v219, 0
    v_mov_b32 v220, 0
    v_mov_b32 v221, 0
    v_mov_b32 v222, 0
    v_mov_b32 v223, 0
    s_mov_b32 s24, s6
    s_mov_b32 s25, s7
    s_mov_b32 s26, 2097152
    s_mov_b32 s27, 0x20000
    s_mov_b32 s36, s46
    s_mov_b32 s37, s47
    s_mov_b32 s38, 2097152
    s_mov_b32 s39, 0x20000
    s_mov_b32 s32, s44
    s_mov_b32 s33, s45
    s_mov_b32 s34, 1024
    s_mov_b32 s35, 0x20000
    v_and_b32 v3, 15, v1
    v_lshrrev_b32 v4, 4, v1
    s_lshl_b32 s22, s29, 6
    s_add_u32 s22, s22, s28
    s_lshl_b32 s23, s18, 5
    s_add_u32 s22, s22, s23
    v_lshl_add_u32 v5, v4, 3, s22
    s_lshr_b32 s22, s16, 1
    s_cmp_eq_u32 s22, 0
    s_cselect_b32 s50, 1, -1
    s_cselect_b32 s51, 0, 2097152
    s_lshl_b32 s50, s50, 10
    s_lshl_b32 s22, s30, 5
    v_add_u32 v6, s22, v3
    s_and_b32 s22, s16, 1
    s_cmp_eq_u32 s22, 0
    s_cselect_b32 s52, 2, -2
    s_cselect_b32 s53, 0, 1024
    v_mov_b32 v7, s53
    v_mad_i32_i24 v242, v6, s52, v7
    v_add_u32 v6, 16, v6
    v_mad_i32_i24 v243, v6, s52, v7
    v_cmp_eq_u32 vcc, 1024, v242
    v_mov_b32 v7, 512
    v_mov_b32 v8, s51
    v_cndmask_b32 v242, v242, v7, vcc
    v_add_u32 v6, 0, v5
    v_mad_i32_i24 v6, v6, s50, v8
    v_cmp_eq_u32 vcc, 2097152, v6
    v_mov_b32 v7, 1048576
    s_nop 0
    v_cndmask_b32 v6, v6, v7, vcc
    v_add_u32 v232, v6, v242
    v_add_u32 v236, v6, v243
    v_add_u32 v6, 2, v5
    v_mad_i32_i24 v6, v6, s50, v8
    v_add_u32 v233, v6, v242
    v_add_u32 v237, v6, v243
    v_add_u32 v6, 4, v5
    v_mad_i32_i24 v6, v6, s50, v8
    v_add_u32 v234, v6, v242
    v_add_u32 v238, v6, v243
    v_add_u32 v6, 6, v5
    v_mad_i32_i24 v6, v6, s50, v8
    v_add_u32 v235, v6, v242
    v_add_u32 v239, v6, v243
    buffer_load_ushort v224, v232, s[24:27], 0 offen
    buffer_load_ushort v225, v233, s[24:27], 0 offen
    buffer_load_ushort v226, v234, s[24:27], 0 offen
    buffer_load_ushort v227, v235, s[24:27], 0 offen
    buffer_load_ushort v228, v236, s[24:27], 0 offen
    buffer_load_ushort v229, v237, s[24:27], 0 offen
    buffer_load_ushort v230, v238, s[24:27], 0 offen
    buffer_load_ushort v231, v239, s[24:27], 0 offen
    buffer_load_ushort v240, v242, s[32:35], 0 offen
    buffer_load_ushort v241, v243, s[32:35], 0 offen
    s_mul_i32 s60, s19, 8
    s_and_b32 s22, s30, 7
    s_add_u32 s60, s60, s22
    s_lshl_b32 s60, s60, 8
    s_add_u32 s60, s60, 15728640
    v_lshlrev_b32 v3, 2, v1
    v_add_u32 v9, s41, v2
    s_cmp_lg_u32 s16, 0
    s_cbranch_scc1 L_p2_zl
    s_mov_b32 s42, -1
    s_mov_b32 s43, 0x7ff
    s_mov_b64 exec, s[42:43]
    s_mov_b32 s23, 0x10000
L_zh_p:
    buffer_load_dword v4, v3, s[8:11], s60 offen sc1
L_zh_t:
    s_sub_u32 s23, s23, 1
    s_waitcnt vmcnt(0)
    v_cmp_ne_u32 vcc, s63, v4
    s_cbranch_vccz L_zh_q
    s_cmp_eq_u32 s23, 0
    s_cbranch_scc1 L_zh_q
    s_sleep 4
    s_branch L_zh_p
L_zh_q:
    s_mov_b64 exec, -1
    v_mov_b32 v3, 162564
    v_mov_b32 v4, 1
    ds_write_b32 v3, v4
    s_branch L_p2_zg
L_p2_zl:
    v_mov_b32 v3, 162564
    s_mov_b32 s23, 0x100000
L_zh_w:
    ds_read_b32 v4, v3
    s_sub_u32 s23, s23, 1
    s_waitcnt lgkmcnt(0)
    v_cmp_ne_u32 vcc, 0, v4
    s_cbranch_vccnz L_zh_x
    s_cmp_eq_u32 s23, 0
    s_cbranch_scc1 L_zh_x
    s_sleep 1
    s_branch L_zh_w
L_zh_x:
L_p2_zg:
    s_cmp_eq_u32 s16, 3
    s_cbranch_scc1 L_k2_z10
    s_add_u32 s56, s48, 0
    buffer_load_dwordx4 v[64:67], v2, s[8:11], s56 offen offset:0 sc1
    buffer_load_dwordx4 v[68:71], v2, s[8:11], s56 offen offset:1024 sc1
    buffer_load_dwordx4 v[72:75], v2, s[8:11], s56 offen offset:2048 sc1
    buffer_load_dwordx4 v[76:79], v2, s[8:11], s56 offen offset:3072 sc1
    s_add_u32 s56, s48, 4096
    buffer_load_dwordx4 v[80:83], v2, s[8:11], s56 offen offset:0 sc1
    buffer_load_dwordx4 v[84:87], v2, s[8:11], s56 offen offset:1024 sc1
    buffer_load_dwordx4 v[88:91], v2, s[8:11], s56 offen offset:2048 sc1
    buffer_load_dwordx4 v[92:95], v2, s[8:11], s56 offen offset:3072 sc1
    s_add_u32 s56, s48, 8192
    buffer_load_dwordx4 v[96:99], v2, s[8:11], s56 offen offset:0 sc1
    buffer_load_dwordx4 v[100:103], v2, s[8:11], s56 offen offset:1024 sc1
    buffer_load_dwordx4 v[104:107], v2, s[8:11], s56 offen offset:2048 sc1
    buffer_load_dwordx4 v[108:111], v2, s[8:11], s56 offen offset:3072 sc1
    v_sub_u32 v11, 16, v1
    v_and_b32 v11, 15, v11
    v_and_or_b32 v11, v1, 48, v11
    v_lshl_add_u32 v11, v11, 4, s41
    s_lshl_b32 s22, s16, 12
    s_add_u32 s22, s22, 2048
    v_add_u32 v3, s22, v2
    v_add_u32 v10, 65536, v3
    s_add_u32 s22, s22, 135168
    v_lshl_add_u32 v5, v1, 3, s22
    s_mov_b32 s52, 0xbfb8aa3b
    s_waitcnt vmcnt(12)
    s_mov_b32 s50, 1.0
    s_mov_b32 s51, 1.0
    s_movk_i32 s53, 0x3f80
    v_lshlrev_b32 v136, 16, v240
    v_mov_b32 v144, 0
    v_lshlrev_b32 v137, 16, v240
    v_mov_b32 v145, 0
    v_lshlrev_b32 v138, 16, v240
    v_mov_b32 v146, 0
    v_lshlrev_b32 v139, 16, v240
    v_mov_b32 v147, 0
    v_lshlrev_b32 v140, 16, v241
    v_mov_b32 v148, 0
    v_lshlrev_b32 v141, 16, v241
    v_mov_b32 v149, 0
    v_lshlrev_b32 v142, 16, v241
    v_mov_b32 v150, 0
    v_lshlrev_b32 v143, 16, v241
    v_mov_b32 v151, 0
    v_lshlrev_b32 v224, 16, v224
    v_lshlrev_b32 v225, 16, v225
    v_lshlrev_b32 v226, 16, v226
    v_lshlrev_b32 v227, 16, v227
    v_lshlrev_b32 v228, 16, v228
    v_lshlrev_b32 v229, 16, v229
    v_lshlrev_b32 v230, 16, v230
    v_lshlrev_b32 v231, 16, v231
    s_waitcnt vmcnt(8)
    v_mfma_f32_16x16x32_bf16 v[160:163], v[64:67], v[16:19], v[160:163]
    v_mfma_f32_16x16x32_bf16 v[164:167], v[64:67], v[20:23], v[164:167]
    v_mfma_f32_16x16x32_bf16 v[168:171], v[64:67], v[24:27], v[168:171]
    v_mfma_f32_16x16x32_bf16 v[172:175], v[64:67], v[28:31], v[172:175]
    s_add_u32 s56, s48, 12288
    buffer_load_dwordx4 v[64:67], v2, s[8:11], s56 offen offset:0 sc1
    v_mfma_f32_16x16x32_bf16 v[176:179], v[68:71], v[16:19], v[176:179]
    v_mfma_f32_16x16x32_bf16 v[180:183], v[68:71], v[20:23], v[180:183]
    v_mfma_f32_16x16x32_bf16 v[184:187], v[68:71], v[24:27], v[184:187]
    v_mfma_f32_16x16x32_bf16 v[188:191], v[68:71], v[28:31], v[188:191]
    buffer_load_dwordx4 v[68:71], v2, s[8:11], s56 offen offset:1024 sc1
    v_mfma_f32_16x16x32_bf16 v[192:195], v[72:75], v[16:19], v[192:195]
    v_mfma_f32_16x16x32_bf16 v[196:199], v[72:75], v[20:23], v[196:199]
    v_mfma_f32_16x16x32_bf16 v[200:203], v[72:75], v[24:27], v[200:203]
    v_mfma_f32_16x16x32_bf16 v[204:207], v[72:75], v[28:31], v[204:207]
    buffer_load_dwordx4 v[72:75], v2, s[8:11], s56 offen offset:2048 sc1
    v_mfma_f32_16x16x32_bf16 v[208:211], v[76:79], v[16:19], v[208:211]
    v_mfma_f32_16x16x32_bf16 v[212:215], v[76:79], v[20:23], v[212:215]
    v_mfma_f32_16x16x32_bf16 v[216:219], v[76:79], v[24:27], v[216:219]
    v_mfma_f32_16x16x32_bf16 v[220:223], v[76:79], v[28:31], v[220:223]
    buffer_load_dwordx4 v[76:79], v2, s[8:11], s56 offen offset:3072 sc1
    s_waitcnt vmcnt(8)
    v_mfma_f32_16x16x32_bf16 v[160:163], v[80:83], v[32:35], v[160:163]
    ds_read_b128 v[16:19], v9 offset:0
    v_mfma_f32_16x16x32_bf16 v[164:167], v[80:83], v[36:39], v[164:167]
    ds_read_b128 v[20:23], v9 offset:1024
    v_mfma_f32_16x16x32_bf16 v[168:171], v[80:83], v[40:43], v[168:171]
    ds_read_b128 v[24:27], v9 offset:2048
    v_mfma_f32_16x16x32_bf16 v[172:175], v[80:83], v[44:47], v[172:175]
    ds_read_b128 v[28:31], v9 offset:3072
    s_add_u32 s56, s48, 16384
    buffer_load_dwordx4 v[80:83], v2, s[8:11], s56 offen offset:0 sc1
    v_mfma_f32_16x16x32_bf16 v[176:179], v[84:87], v[32:35], v[176:179]
    v_mfma_f32_16x16x32_bf16 v[180:183], v[84:87], v[36:39], v[180:183]
    v_mfma_f32_16x16x32_bf16 v[184:187], v[84:87], v[40:43], v[184:187]
    v_mfma_f32_16x16x32_bf16 v[188:191], v[84:87], v[44:47], v[188:191]
    buffer_load_dwordx4 v[84:87], v2, s[8:11], s56 offen offset:1024 sc1
    v_mfma_f32_16x16x32_bf16 v[192:195], v[88:91], v[32:35], v[192:195]
    v_mfma_f32_16x16x32_bf16 v[196:199], v[88:91], v[36:39], v[196:199]
    v_mfma_f32_16x16x32_bf16 v[200:203], v[88:91], v[40:43], v[200:203]
    v_mfma_f32_16x16x32_bf16 v[204:207], v[88:91], v[44:47], v[204:207]
    buffer_load_dwordx4 v[88:91], v2, s[8:11], s56 offen offset:2048 sc1
    v_mfma_f32_16x16x32_bf16 v[208:211], v[92:95], v[32:35], v[208:211]
    v_mfma_f32_16x16x32_bf16 v[212:215], v[92:95], v[36:39], v[212:215]
    v_mfma_f32_16x16x32_bf16 v[216:219], v[92:95], v[40:43], v[216:219]
    v_mfma_f32_16x16x32_bf16 v[220:223], v[92:95], v[44:47], v[220:223]
    buffer_load_dwordx4 v[92:95], v2, s[8:11], s56 offen offset:3072 sc1
    s_waitcnt vmcnt(8)
    v_mfma_f32_16x16x32_bf16 v[160:163], v[96:99], v[48:51], v[160:163]
    ds_read_b128 v[32:35], v9 offset:4096
    v_mfma_f32_16x16x32_bf16 v[164:167], v[96:99], v[52:55], v[164:167]
    ds_read_b128 v[36:39], v9 offset:5120
    v_mfma_f32_16x16x32_bf16 v[168:171], v[96:99], v[56:59], v[168:171]
    ds_read_b128 v[40:43], v9 offset:6144
    v_mfma_f32_16x16x32_bf16 v[172:175], v[96:99], v[60:63], v[172:175]
    ds_read_b128 v[44:47], v9 offset:7168
    s_add_u32 s56, s48, 20480
    buffer_load_dwordx4 v[96:99], v2, s[8:11], s56 offen offset:0 sc1
    v_mfma_f32_16x16x32_bf16 v[176:179], v[100:103], v[48:51], v[176:179]
    v_mfma_f32_16x16x32_bf16 v[180:183], v[100:103], v[52:55], v[180:183]
    v_mfma_f32_16x16x32_bf16 v[184:187], v[100:103], v[56:59], v[184:187]
    v_mfma_f32_16x16x32_bf16 v[188:191], v[100:103], v[60:63], v[188:191]
    buffer_load_dwordx4 v[100:103], v2, s[8:11], s56 offen offset:1024 sc1
    v_mfma_f32_16x16x32_bf16 v[192:195], v[104:107], v[48:51], v[192:195]
    v_mfma_f32_16x16x32_bf16 v[196:199], v[104:107], v[52:55], v[196:199]
    v_mfma_f32_16x16x32_bf16 v[200:203], v[104:107], v[56:59], v[200:203]
    v_mfma_f32_16x16x32_bf16 v[204:207], v[104:107], v[60:63], v[204:207]
    buffer_load_dwordx4 v[104:107], v2, s[8:11], s56 offen offset:2048 sc1
    v_mfma_f32_16x16x32_bf16 v[208:211], v[108:111], v[48:51], v[208:211]
    v_mfma_f32_16x16x32_bf16 v[212:215], v[108:111], v[52:55], v[212:215]
    v_mfma_f32_16x16x32_bf16 v[216:219], v[108:111], v[56:59], v[216:219]
    v_mfma_f32_16x16x32_bf16 v[220:223], v[108:111], v[60:63], v[220:223]
    buffer_load_dwordx4 v[108:111], v2, s[8:11], s56 offen offset:3072 sc1
    s_waitcnt vmcnt(8)
    s_waitcnt lgkmcnt(4)
    v_mfma_f32_16x16x32_bf16 v[160:163], v[64:67], v[16:19], v[160:163]
    ds_read_b128 v[48:51], v9 offset:8192
    v_mfma_f32_16x16x32_bf16 v[164:167], v[64:67], v[20:23], v[164:167]
    ds_read_b128 v[52:55], v9 offset:9216
    v_mfma_f32_16x16x32_bf16 v[168:171], v[64:67], v[24:27], v[168:171]
    ds_read_b128 v[56:59], v9 offset:10240
    v_mfma_f32_16x16x32_bf16 v[172:175], v[64:67], v[28:31], v[172:175]
    ds_read_b128 v[60:63], v9 offset:11264
    s_add_u32 s56, s48, 24576
    buffer_load_dwordx4 v[64:67], v2, s[8:11], s56 offen offset:0 sc1
    v_mfma_f32_16x16x32_bf16 v[176:179], v[68:71], v[16:19], v[176:179]
    v_mfma_f32_16x16x32_bf16 v[180:183], v[68:71], v[20:23], v[180:183]
    v_mfma_f32_16x16x32_bf16 v[184:187], v[68:71], v[24:27], v[184:187]
    v_mfma_f32_16x16x32_bf16 v[188:191], v[68:71], v[28:31], v[188:191]
    buffer_load_dwordx4 v[68:71], v2, s[8:11], s56 offen offset:1024 sc1
    v_mfma_f32_16x16x32_bf16 v[192:195], v[72:75], v[16:19], v[192:195]
    v_mfma_f32_16x16x32_bf16 v[196:199], v[72:75], v[20:23], v[196:199]
    v_mfma_f32_16x16x32_bf16 v[200:203], v[72:75], v[24:27], v[200:203]
    v_mfma_f32_16x16x32_bf16 v[204:207], v[72:75], v[28:31], v[204:207]
    buffer_load_dwordx4 v[72:75], v2, s[8:11], s56 offen offset:2048 sc1
    v_mfma_f32_16x16x32_bf16 v[208:211], v[76:79], v[16:19], v[208:211]
    v_mfma_f32_16x16x32_bf16 v[212:215], v[76:79], v[20:23], v[212:215]
    v_mfma_f32_16x16x32_bf16 v[216:219], v[76:79], v[24:27], v[216:219]
    v_mfma_f32_16x16x32_bf16 v[220:223], v[76:79], v[28:31], v[220:223]
    buffer_load_dwordx4 v[76:79], v2, s[8:11], s56 offen offset:3072 sc1
    s_waitcnt vmcnt(8)
    s_waitcnt lgkmcnt(4)
    v_mfma_f32_16x16x32_bf16 v[160:163], v[80:83], v[32:35], v[160:163]
    ds_read_b128 v[16:19], v9 offset:12288
    v_mfma_f32_16x16x32_bf16 v[164:167], v[80:83], v[36:39], v[164:167]
    ds_read_b128 v[20:23], v9 offset:13312
    v_mfma_f32_16x16x32_bf16 v[168:171], v[80:83], v[40:43], v[168:171]
    ds_read_b128 v[24:27], v9 offset:14336
    v_mfma_f32_16x16x32_bf16 v[172:175], v[80:83], v[44:47], v[172:175]
    ds_read_b128 v[28:31], v9 offset:15360
    s_add_u32 s56, s48, 28672
    buffer_load_dwordx4 v[80:83], v2, s[8:11], s56 offen offset:0 sc1
    v_mfma_f32_16x16x32_bf16 v[176:179], v[84:87], v[32:35], v[176:179]
    v_mfma_f32_16x16x32_bf16 v[180:183], v[84:87], v[36:39], v[180:183]
    v_mfma_f32_16x16x32_bf16 v[184:187], v[84:87], v[40:43], v[184:187]
    v_mfma_f32_16x16x32_bf16 v[188:191], v[84:87], v[44:47], v[188:191]
    buffer_load_dwordx4 v[84:87], v2, s[8:11], s56 offen offset:1024 sc1
    v_mfma_f32_16x16x32_bf16 v[192:195], v[88:91], v[32:35], v[192:195]
    v_mfma_f32_16x16x32_bf16 v[196:199], v[88:91], v[36:39], v[196:199]
    v_mfma_f32_16x16x32_bf16 v[200:203], v[88:91], v[40:43], v[200:203]
    v_mfma_f32_16x16x32_bf16 v[204:207], v[88:91], v[44:47], v[204:207]
    buffer_load_dwordx4 v[88:91], v2, s[8:11], s56 offen offset:2048 sc1
    v_mfma_f32_16x16x32_bf16 v[208:211], v[92:95], v[32:35], v[208:211]
    v_mfma_f32_16x16x32_bf16 v[212:215], v[92:95], v[36:39], v[212:215]
    v_mfma_f32_16x16x32_bf16 v[216:219], v[92:95], v[40:43], v[216:219]
    v_mfma_f32_16x16x32_bf16 v[220:223], v[92:95], v[44:47], v[220:223]
    buffer_load_dwordx4 v[92:95], v2, s[8:11], s56 offen offset:3072 sc1
    s_waitcnt vmcnt(8)
    s_waitcnt lgkmcnt(4)
    v_mfma_f32_16x16x32_bf16 v[160:163], v[96:99], v[48:51], v[160:163]
    ds_read_b128 v[32:35], v9 offset:16384
    v_mfma_f32_16x16x32_bf16 v[164:167], v[96:99], v[52:55], v[164:167]
    ds_read_b128 v[36:39], v9 offset:17408
    v_mfma_f32_16x16x32_bf16 v[168:171], v[96:99], v[56:59], v[168:171]
    ds_read_b128 v[40:43], v9 offset:18432
    v_mfma_f32_16x16x32_bf16 v[172:175], v[96:99], v[60:63], v[172:175]
    ds_read_b128 v[44:47], v9 offset:19456
    s_add_u32 s56, s48, 32768
    buffer_load_dwordx4 v[96:99], v2, s[8:11], s56 offen offset:0 sc1
    v_mfma_f32_16x16x32_bf16 v[176:179], v[100:103], v[48:51], v[176:179]
    v_mfma_f32_16x16x32_bf16 v[180:183], v[100:103], v[52:55], v[180:183]
    v_mfma_f32_16x16x32_bf16 v[184:187], v[100:103], v[56:59], v[184:187]
    v_mfma_f32_16x16x32_bf16 v[188:191], v[100:103], v[60:63], v[188:191]
    buffer_load_dwordx4 v[100:103], v2, s[8:11], s56 offen offset:1024 sc1
    v_mfma_f32_16x16x32_bf16 v[192:195], v[104:107], v[48:51], v[192:195]
    v_mfma_f32_16x16x32_bf16 v[196:199], v[104:107], v[52:55], v[196:199]
    v_mfma_f32_16x16x32_bf16 v[200:203], v[104:107], v[56:59], v[200:203]
    v_mfma_f32_16x16x32_bf16 v[204:207], v[104:107], v[60:63], v[204:207]
    buffer_load_dwordx4 v[104:107], v2, s[8:11], s56 offen offset:2048 sc1
    v_mfma_f32_16x16x32_bf16 v[208:211], v[108:111], v[48:51], v[208:211]
    v_mfma_f32_16x16x32_bf16 v[212:215], v[108:111], v[52:55], v[212:215]
    v_mfma_f32_16x16x32_bf16 v[216:219], v[108:111], v[56:59], v[216:219]
    v_mfma_f32_16x16x32_bf16 v[220:223], v[108:111], v[60:63], v[220:223]
    buffer_load_dwordx4 v[108:111], v2, s[8:11], s56 offen offset:3072 sc1
    s_waitcnt vmcnt(8)
    s_waitcnt lgkmcnt(4)
    v_mfma_f32_16x16x32_bf16 v[160:163], v[64:67], v[16:19], v[160:163]
    ds_read_b128 v[48:51], v9 offset:20480
    v_mfma_f32_16x16x32_bf16 v[164:167], v[64:67], v[20:23], v[164:167]
    ds_read_b128 v[52:55], v9 offset:21504
    v_mfma_f32_16x16x32_bf16 v[168:171], v[64:67], v[24:27], v[168:171]
    ds_read_b128 v[56:59], v9 offset:22528
    v_mfma_f32_16x16x32_bf16 v[172:175], v[64:67], v[28:31], v[172:175]
    ds_read_b128 v[60:63], v9 offset:23552
    s_add_u32 s56, s48, 36864
    buffer_load_dwordx4 v[64:67], v2, s[8:11], s56 offen offset:0 sc1
    v_mfma_f32_16x16x32_bf16 v[176:179], v[68:71], v[16:19], v[176:179]
    v_mfma_f32_16x16x32_bf16 v[180:183], v[68:71], v[20:23], v[180:183]
    v_mfma_f32_16x16x32_bf16 v[184:187], v[68:71], v[24:27], v[184:187]
    v_mfma_f32_16x16x32_bf16 v[188:191], v[68:71], v[28:31], v[188:191]
    buffer_load_dwordx4 v[68:71], v2, s[8:11], s56 offen offset:1024 sc1
    v_mfma_f32_16x16x32_bf16 v[192:195], v[72:75], v[16:19], v[192:195]
    v_mfma_f32_16x16x32_bf16 v[196:199], v[72:75], v[20:23], v[196:199]
    v_mfma_f32_16x16x32_bf16 v[200:203], v[72:75], v[24:27], v[200:203]
    v_mfma_f32_16x16x32_bf16 v[204:207], v[72:75], v[28:31], v[204:207]
    buffer_load_dwordx4 v[72:75], v2, s[8:11], s56 offen offset:2048 sc1
    v_mfma_f32_16x16x32_bf16 v[208:211], v[76:79], v[16:19], v[208:211]
    v_mfma_f32_16x16x32_bf16 v[212:215], v[76:79], v[20:23], v[212:215]
    v_mfma_f32_16x16x32_bf16 v[216:219], v[76:79], v[24:27], v[216:219]
    v_mfma_f32_16x16x32_bf16 v[220:223], v[76:79], v[28:31], v[220:223]
    buffer_load_dwordx4 v[76:79], v2, s[8:11], s56 offen offset:3072 sc1
    s_waitcnt vmcnt(8)
    s_waitcnt lgkmcnt(4)
    v_mfma_f32_16x16x32_bf16 v[160:163], v[80:83], v[32:35], v[160:163]
    ds_read_b128 v[16:19], v9 offset:24576
    v_mfma_f32_16x16x32_bf16 v[164:167], v[80:83], v[36:39], v[164:167]
    ds_read_b128 v[20:23], v9 offset:25600
    v_mfma_f32_16x16x32_bf16 v[168:171], v[80:83], v[40:43], v[168:171]
    ds_read_b128 v[24:27], v9 offset:26624
    v_mfma_f32_16x16x32_bf16 v[172:175], v[80:83], v[44:47], v[172:175]
    ds_read_b128 v[28:31], v9 offset:27648
    s_add_u32 s56, s48, 40960
    buffer_load_dwordx4 v[80:83], v2, s[8:11], s56 offen offset:0 sc1
    v_mfma_f32_16x16x32_bf16 v[176:179], v[84:87], v[32:35], v[176:179]
    v_mfma_f32_16x16x32_bf16 v[180:183], v[84:87], v[36:39], v[180:183]
    v_mfma_f32_16x16x32_bf16 v[184:187], v[84:87], v[40:43], v[184:187]
    v_mfma_f32_16x16x32_bf16 v[188:191], v[84:87], v[44:47], v[188:191]
    buffer_load_dwordx4 v[84:87], v2, s[8:11], s56 offen offset:1024 sc1
    v_mfma_f32_16x16x32_bf16 v[192:195], v[88:91], v[32:35], v[192:195]
    v_mfma_f32_16x16x32_bf16 v[196:199], v[88:91], v[36:39], v[196:199]
    v_mfma_f32_16x16x32_bf16 v[200:203], v[88:91], v[40:43], v[200:203]
    v_mfma_f32_16x16x32_bf16 v[204:207], v[88:91], v[44:47], v[204:207]
    buffer_load_dwordx4 v[88:91], v2, s[8:11], s56 offen offset:2048 sc1
    v_mfma_f32_16x16x32_bf16 v[208:211], v[92:95], v[32:35], v[208:211]
    v_mfma_f32_16x16x32_bf16 v[212:215], v[92:95], v[36:39], v[212:215]
    v_mfma_f32_16x16x32_bf16 v[216:219], v[92:95], v[40:43], v[216:219]
    v_mfma_f32_16x16x32_bf16 v[220:223], v[92:95], v[44:47], v[220:223]
    buffer_load_dwordx4 v[92:95], v2, s[8:11], s56 offen offset:3072 sc1
    s_waitcnt vmcnt(8)
    s_waitcnt lgkmcnt(4)
    v_mfma_f32_16x16x32_bf16 v[160:163], v[96:99], v[48:51], v[160:163]
    ds_read_b128 v[32:35], v9 offset:28672
    v_mfma_f32_16x16x32_bf16 v[164:167], v[96:99], v[52:55], v[164:167]
    ds_read_b128 v[36:39], v9 offset:29696
    v_mfma_f32_16x16x32_bf16 v[168:171], v[96:99], v[56:59], v[168:171]
    ds_read_b128 v[40:43], v9 offset:30720
    v_mfma_f32_16x16x32_bf16 v[172:175], v[96:99], v[60:63], v[172:175]
    ds_read_b128 v[44:47], v9 offset:31744
    v_mfma_f32_16x16x32_bf16 v[176:179], v[100:103], v[48:51], v[176:179]
    v_mfma_f32_16x16x32_bf16 v[180:183], v[100:103], v[52:55], v[180:183]
    v_mfma_f32_16x16x32_bf16 v[184:187], v[100:103], v[56:59], v[184:187]
    v_mfma_f32_16x16x32_bf16 v[188:191], v[100:103], v[60:63], v[188:191]
    v_mfma_f32_16x16x32_bf16 v[192:195], v[104:107], v[48:51], v[192:195]
    v_mfma_f32_16x16x32_bf16 v[196:199], v[104:107], v[52:55], v[196:199]
    v_mfma_f32_16x16x32_bf16 v[200:203], v[104:107], v[56:59], v[200:203]
    v_mfma_f32_16x16x32_bf16 v[204:207], v[104:107], v[60:63], v[204:207]
    v_mfma_f32_16x16x32_bf16 v[208:211], v[108:111], v[48:51], v[208:211]
    v_mfma_f32_16x16x32_bf16 v[212:215], v[108:111], v[52:55], v[212:215]
    v_mfma_f32_16x16x32_bf16 v[216:219], v[108:111], v[56:59], v[216:219]
    v_mfma_f32_16x16x32_bf16 v[220:223], v[108:111], v[60:63], v[220:223]
    s_waitcnt vmcnt(4)
    s_waitcnt lgkmcnt(4)
    v_mfma_f32_16x16x32_bf16 v[160:163], v[64:67], v[16:19], v[160:163]
    v_mfma_f32_16x16x32_bf16 v[164:167], v[64:67], v[20:23], v[164:167]
    v_mfma_f32_16x16x32_bf16 v[168:171], v[64:67], v[24:27], v[168:171]
    v_mfma_f32_16x16x32_bf16 v[172:175], v[64:67], v[28:31], v[172:175]
    v_mfma_f32_16x16x32_bf16 v[176:179], v[68:71], v[16:19], v[176:179]
    v_mfma_f32_16x16x32_bf16 v[180:183], v[68:71], v[20:23], v[180:183]
    v_mfma_f32_16x16x32_bf16 v[184:187], v[68:71], v[24:27], v[184:187]
    v_mfma_f32_16x16x32_bf16 v[188:191], v[68:71], v[28:31], v[188:191]
    v_mfma_f32_16x16x32_bf16 v[192:195], v[72:75], v[16:19], v[192:195]
    v_mfma_f32_16x16x32_bf16 v[196:199], v[72:75], v[20:23], v[196:199]
    v_mfma_f32_16x16x32_bf16 v[200:203], v[72:75], v[24:27], v[200:203]
    v_mfma_f32_16x16x32_bf16 v[204:207], v[72:75], v[28:31], v[204:207]
    v_mfma_f32_16x16x32_bf16 v[208:211], v[76:79], v[16:19], v[208:211]
    v_mfma_f32_16x16x32_bf16 v[212:215], v[76:79], v[20:23], v[212:215]
    v_mfma_f32_16x16x32_bf16 v[216:219], v[76:79], v[24:27], v[216:219]
    v_mfma_f32_16x16x32_bf16 v[220:223], v[76:79], v[28:31], v[220:223]
    s_waitcnt vmcnt(0)
    s_waitcnt lgkmcnt(0)
    v_mfma_f32_16x16x32_bf16 v[160:163], v[80:83], v[32:35], v[160:163]
    v_mfma_f32_16x16x32_bf16 v[164:167], v[80:83], v[36:39], v[164:167]
    v_mfma_f32_16x16x32_bf16 v[168:171], v[80:83], v[40:43], v[168:171]
    v_mfma_f32_16x16x32_bf16 v[172:175], v[80:83], v[44:47], v[172:175]
    v_mfma_f32_16x16x32_bf16 v[176:179], v[84:87], v[32:35], v[176:179]
    v_mfma_f32_16x16x32_bf16 v[180:183], v[84:87], v[36:39], v[180:183]
    v_mfma_f32_16x16x32_bf16 v[184:187], v[84:87], v[40:43], v[184:187]
    v_mfma_f32_16x16x32_bf16 v[188:191], v[84:87], v[44:47], v[188:191]
    v_mfma_f32_16x16x32_bf16 v[192:195], v[88:91], v[32:35], v[192:195]
    ds_write_b128 v9, v[160:163] offset:0
    ds_write_b128 v9, v[164:167] offset:1024
    v_mfma_f32_16x16x32_bf16 v[196:199], v[88:91], v[36:39], v[196:199]
    ds_write_b128 v11, v[168:171] offset:4096
    ds_write_b128 v11, v[172:175] offset:5120
    v_mfma_f32_16x16x32_bf16 v[200:203], v[88:91], v[40:43], v[200:203]
    ds_write_b128 v9, v[176:179] offset:2048
    ds_write_b128 v9, v[180:183] offset:3072
    v_mfma_f32_16x16x32_bf16 v[204:207], v[88:91], v[44:47], v[204:207]
    ds_write_b128 v11, v[184:187] offset:6144
    ds_write_b128 v11, v[188:191] offset:7168
    v_mfma_f32_16x16x32_bf16 v[208:211], v[92:95], v[32:35], v[208:211]
    ds_write_b128 v9, v[192:195] offset:8192
    ds_write_b128 v9, v[196:199] offset:9216
    v_mfma_f32_16x16x32_bf16 v[212:215], v[92:95], v[36:39], v[212:215]
    ds_write_b128 v11, v[200:203] offset:12288
    v_mfma_f32_16x16x32_bf16 v[216:219], v[92:95], v[40:43], v[216:219]
    ds_write_b128 v11, v[204:207] offset:13312
    v_mfma_f32_16x16x32_bf16 v[220:223], v[92:95], v[44:47], v[220:223]
    s_nop 0
    ds_write_b128 v9, v[208:211] offset:10240
    s_nop 1
    ds_write_b128 v9, v[212:215] offset:11264
    s_nop 0
    ds_write_b128 v11, v[216:219] offset:14336
    s_nop 0
    ds_write_b128 v11, v[220:223] offset:15360
    s_branch L_k2_final
L_k2_z10:
    s_add_u32 s56, s48, 0
    buffer_load_dwordx4 v[64:67], v2, s[8:11], s56 offen offset:0 sc1
    buffer_load_dwordx4 v[68:71], v2, s[8:11], s56 offen offset:1024 sc1
    buffer_load_dwordx4 v[72:75], v2, s[8:11], s56 offen offset:2048 sc1
    buffer_load_dwordx4 v[76:79], v2, s[8:11], s56 offen offset:3072 sc1
    s_add_u32 s56, s48, 4096
    buffer_load_dwordx4 v[80:83], v2, s[8:11], s56 offen offset:0 sc1
    buffer_load_dwordx4 v[84:87], v2, s[8:11], s56 offen offset:1024 sc1
    buffer_load_dwordx4 v[88:91], v2, s[8:11], s56 offen offset:2048 sc1
    buffer_load_dwordx4 v[92:95], v2, s[8:11], s56 offen offset:3072 sc1
    s_add_u32 s56, s48, 8192
    buffer_load_dwordx4 v[96:99], v2, s[8:11], s56 offen offset:0 sc1
    buffer_load_dwordx4 v[100:103], v2, s[8:11], s56 offen offset:1024 sc1
    buffer_load_dwordx4 v[104:107], v2, s[8:11], s56 offen offset:2048 sc1
    buffer_load_dwordx4 v[108:111], v2, s[8:11], s56 offen offset:3072 sc1
    v_sub_u32 v11, 16, v1
    v_and_b32 v11, 15, v11
    v_and_or_b32 v11, v1, 48, v11
    v_lshl_add_u32 v11, v11, 4, s41
    s_lshl_b32 s22, s16, 12
    s_add_u32 s22, s22, 2048
    v_add_u32 v3, s22, v2
    v_add_u32 v10, 65536, v3
    s_add_u32 s22, s22, 135168
    v_lshl_add_u32 v5, v1, 3, s22
    s_mov_b32 s52, 0xbfb8aa3b
    s_waitcnt vmcnt(12)
    s_mov_b32 s50, 1.0
    s_mov_b32 s51, 1.0
    s_movk_i32 s53, 0x3f80
    v_lshlrev_b32 v136, 16, v240
    v_mov_b32 v144, 0
    v_lshlrev_b32 v137, 16, v240
    v_mov_b32 v145, 0
    v_lshlrev_b32 v138, 16, v240
    v_mov_b32 v146, 0
    v_lshlrev_b32 v139, 16, v240
    v_mov_b32 v147, 0
    v_lshlrev_b32 v140, 16, v241
    v_mov_b32 v148, 0
    v_lshlrev_b32 v141, 16, v241
    v_mov_b32 v149, 0
    v_lshlrev_b32 v142, 16, v241
    v_mov_b32 v150, 0
    v_lshlrev_b32 v143, 16, v241
    v_mov_b32 v151, 0
    v_lshlrev_b32 v224, 16, v224
    v_lshlrev_b32 v225, 16, v225
    v_lshlrev_b32 v226, 16, v226
    v_lshlrev_b32 v227, 16, v227
    v_lshlrev_b32 v228, 16, v228
    v_lshlrev_b32 v229, 16, v229
    v_lshlrev_b32 v230, 16, v230
    v_lshlrev_b32 v231, 16, v231
    s_waitcnt vmcnt(8)
    v_mfma_f32_16x16x32_bf16 v[160:163], v[64:67], v[16:19], v[160:163]
    v_mfma_f32_16x16x32_bf16 v[164:167], v[64:67], v[20:23], v[164:167]
    v_mfma_f32_16x16x32_bf16 v[168:171], v[64:67], v[24:27], v[168:171]
    v_mfma_f32_16x16x32_bf16 v[172:175], v[64:67], v[28:31], v[172:175]
    s_add_u32 s56, s48, 12288
    buffer_load_dwordx4 v[64:67], v2, s[8:11], s56 offen offset:0 sc1
    v_mfma_f32_16x16x32_bf16 v[176:179], v[68:71], v[16:19], v[176:179]
    v_mfma_f32_16x16x32_bf16 v[180:183], v[68:71], v[20:23], v[180:183]
    v_mfma_f32_16x16x32_bf16 v[184:187], v[68:71], v[24:27], v[184:187]
    v_mfma_f32_16x16x32_bf16 v[188:191], v[68:71], v[28:31], v[188:191]
    buffer_load_dwordx4 v[68:71], v2, s[8:11], s56 offen offset:1024 sc1
    v_mfma_f32_16x16x32_bf16 v[192:195], v[72:75], v[16:19], v[192:195]
    v_mfma_f32_16x16x32_bf16 v[196:199], v[72:75], v[20:23], v[196:199]
    v_mfma_f32_16x16x32_bf16 v[200:203], v[72:75], v[24:27], v[200:203]
    v_mfma_f32_16x16x32_bf16 v[204:207], v[72:75], v[28:31], v[204:207]
    buffer_load_dwordx4 v[72:75], v2, s[8:11], s56 offen offset:2048 sc1
    v_mfma_f32_16x16x32_bf16 v[208:211], v[76:79], v[16:19], v[208:211]
    v_mfma_f32_16x16x32_bf16 v[212:215], v[76:79], v[20:23], v[212:215]
    v_mfma_f32_16x16x32_bf16 v[216:219], v[76:79], v[24:27], v[216:219]
    v_mfma_f32_16x16x32_bf16 v[220:223], v[76:79], v[28:31], v[220:223]
    buffer_load_dwordx4 v[76:79], v2, s[8:11], s56 offen offset:3072 sc1
    s_waitcnt vmcnt(8)
    v_mfma_f32_16x16x32_bf16 v[160:163], v[80:83], v[32:35], v[160:163]
    ds_read_b128 v[16:19], v9 offset:0
    v_mfma_f32_16x16x32_bf16 v[164:167], v[80:83], v[36:39], v[164:167]
    ds_read_b128 v[20:23], v9 offset:1024
    v_mfma_f32_16x16x32_bf16 v[168:171], v[80:83], v[40:43], v[168:171]
    ds_read_b128 v[24:27], v9 offset:2048
    v_mfma_f32_16x16x32_bf16 v[172:175], v[80:83], v[44:47], v[172:175]
    ds_read_b128 v[28:31], v9 offset:3072
    s_add_u32 s56, s48, 16384
    buffer_load_dwordx4 v[80:83], v2, s[8:11], s56 offen offset:0 sc1
    v_mfma_f32_16x16x32_bf16 v[176:179], v[84:87], v[32:35], v[176:179]
    v_mfma_f32_16x16x32_bf16 v[180:183], v[84:87], v[36:39], v[180:183]
    v_mfma_f32_16x16x32_bf16 v[184:187], v[84:87], v[40:43], v[184:187]
    v_mfma_f32_16x16x32_bf16 v[188:191], v[84:87], v[44:47], v[188:191]
    buffer_load_dwordx4 v[84:87], v2, s[8:11], s56 offen offset:1024 sc1
    v_mfma_f32_16x16x32_bf16 v[192:195], v[88:91], v[32:35], v[192:195]
    v_mfma_f32_16x16x32_bf16 v[196:199], v[88:91], v[36:39], v[196:199]
    v_mfma_f32_16x16x32_bf16 v[200:203], v[88:91], v[40:43], v[200:203]
    v_mfma_f32_16x16x32_bf16 v[204:207], v[88:91], v[44:47], v[204:207]
    buffer_load_dwordx4 v[88:91], v2, s[8:11], s56 offen offset:2048 sc1
    v_mfma_f32_16x16x32_bf16 v[208:211], v[92:95], v[32:35], v[208:211]
    v_mfma_f32_16x16x32_bf16 v[212:215], v[92:95], v[36:39], v[212:215]
    v_mfma_f32_16x16x32_bf16 v[216:219], v[92:95], v[40:43], v[216:219]
    v_mfma_f32_16x16x32_bf16 v[220:223], v[92:95], v[44:47], v[220:223]
    buffer_load_dwordx4 v[92:95], v2, s[8:11], s56 offen offset:3072 sc1
    s_waitcnt vmcnt(8)
    v_mfma_f32_16x16x32_bf16 v[160:163], v[96:99], v[48:51], v[160:163]
    ds_read_b128 v[32:35], v9 offset:4096
    v_mfma_f32_16x16x32_bf16 v[164:167], v[96:99], v[52:55], v[164:167]
    ds_read_b128 v[36:39], v9 offset:5120
    v_mfma_f32_16x16x32_bf16 v[168:171], v[96:99], v[56:59], v[168:171]
    ds_read_b128 v[40:43], v9 offset:6144
    v_mfma_f32_16x16x32_bf16 v[172:175], v[96:99], v[60:63], v[172:175]
    ds_read_b128 v[44:47], v9 offset:7168
    s_add_u32 s56, s48, 20480
    buffer_load_dwordx4 v[96:99], v2, s[8:11], s56 offen offset:0 sc1
    v_mfma_f32_16x16x32_bf16 v[176:179], v[100:103], v[48:51], v[176:179]
    v_mfma_f32_16x16x32_bf16 v[180:183], v[100:103], v[52:55], v[180:183]
    v_mfma_f32_16x16x32_bf16 v[184:187], v[100:103], v[56:59], v[184:187]
    v_mfma_f32_16x16x32_bf16 v[188:191], v[100:103], v[60:63], v[188:191]
    buffer_load_dwordx4 v[100:103], v2, s[8:11], s56 offen offset:1024 sc1
    v_mfma_f32_16x16x32_bf16 v[192:195], v[104:107], v[48:51], v[192:195]
    v_mfma_f32_16x16x32_bf16 v[196:199], v[104:107], v[52:55], v[196:199]
    v_mfma_f32_16x16x32_bf16 v[200:203], v[104:107], v[56:59], v[200:203]
    v_mfma_f32_16x16x32_bf16 v[204:207], v[104:107], v[60:63], v[204:207]
    buffer_load_dwordx4 v[104:107], v2, s[8:11], s56 offen offset:2048 sc1
    v_mfma_f32_16x16x32_bf16 v[208:211], v[108:111], v[48:51], v[208:211]
    v_mfma_f32_16x16x32_bf16 v[212:215], v[108:111], v[52:55], v[212:215]
    v_mfma_f32_16x16x32_bf16 v[216:219], v[108:111], v[56:59], v[216:219]
    v_mfma_f32_16x16x32_bf16 v[220:223], v[108:111], v[60:63], v[220:223]
    buffer_load_dwordx4 v[108:111], v2, s[8:11], s56 offen offset:3072 sc1
    s_waitcnt vmcnt(8)
    s_waitcnt lgkmcnt(4)
    v_mfma_f32_16x16x32_bf16 v[160:163], v[64:67], v[16:19], v[160:163]
    ds_read_b128 v[48:51], v9 offset:8192
    v_mfma_f32_16x16x32_bf16 v[164:167], v[64:67], v[20:23], v[164:167]
    ds_read_b128 v[52:55], v9 offset:9216
    v_mfma_f32_16x16x32_bf16 v[168:171], v[64:67], v[24:27], v[168:171]
    ds_read_b128 v[56:59], v9 offset:10240
    v_mfma_f32_16x16x32_bf16 v[172:175], v[64:67], v[28:31], v[172:175]
    ds_read_b128 v[60:63], v9 offset:11264
    s_add_u32 s56, s48, 24576
    buffer_load_dwordx4 v[64:67], v2, s[8:11], s56 offen offset:0 sc1
    v_mfma_f32_16x16x32_bf16 v[176:179], v[68:71], v[16:19], v[176:179]
    v_mfma_f32_16x16x32_bf16 v[180:183], v[68:71], v[20:23], v[180:183]
    v_mfma_f32_16x16x32_bf16 v[184:187], v[68:71], v[24:27], v[184:187]
    v_mfma_f32_16x16x32_bf16 v[188:191], v[68:71], v[28:31], v[188:191]
    buffer_load_dwordx4 v[68:71], v2, s[8:11], s56 offen offset:1024 sc1
    v_mfma_f32_16x16x32_bf16 v[192:195], v[72:75], v[16:19], v[192:195]
    v_mfma_f32_16x16x32_bf16 v[196:199], v[72:75], v[20:23], v[196:199]
    v_mfma_f32_16x16x32_bf16 v[200:203], v[72:75], v[24:27], v[200:203]
    v_mfma_f32_16x16x32_bf16 v[204:207], v[72:75], v[28:31], v[204:207]
    buffer_load_dwordx4 v[72:75], v2, s[8:11], s56 offen offset:2048 sc1
    v_mfma_f32_16x16x32_bf16 v[208:211], v[76:79], v[16:19], v[208:211]
    v_mfma_f32_16x16x32_bf16 v[212:215], v[76:79], v[20:23], v[212:215]
    v_mfma_f32_16x16x32_bf16 v[216:219], v[76:79], v[24:27], v[216:219]
    v_mfma_f32_16x16x32_bf16 v[220:223], v[76:79], v[28:31], v[220:223]
    buffer_load_dwordx4 v[76:79], v2, s[8:11], s56 offen offset:3072 sc1
    s_waitcnt vmcnt(8)
    s_waitcnt lgkmcnt(4)
    v_mfma_f32_16x16x32_bf16 v[160:163], v[80:83], v[32:35], v[160:163]
    ds_read_b128 v[16:19], v9 offset:12288
    v_mfma_f32_16x16x32_bf16 v[164:167], v[80:83], v[36:39], v[164:167]
    ds_read_b128 v[20:23], v9 offset:13312
    v_mfma_f32_16x16x32_bf16 v[168:171], v[80:83], v[40:43], v[168:171]
    ds_read_b128 v[24:27], v9 offset:14336
    v_mfma_f32_16x16x32_bf16 v[172:175], v[80:83], v[44:47], v[172:175]
    ds_read_b128 v[28:31], v9 offset:15360
    s_add_u32 s56, s48, 28672
    buffer_load_dwordx4 v[80:83], v2, s[8:11], s56 offen offset:0 sc1
    v_mfma_f32_16x16x32_bf16 v[176:179], v[84:87], v[32:35], v[176:179]
    v_mfma_f32_16x16x32_bf16 v[180:183], v[84:87], v[36:39], v[180:183]
    v_mfma_f32_16x16x32_bf16 v[184:187], v[84:87], v[40:43], v[184:187]
    v_mfma_f32_16x16x32_bf16 v[188:191], v[84:87], v[44:47], v[188:191]
    buffer_load_dwordx4 v[84:87], v2, s[8:11], s56 offen offset:1024 sc1
    v_mfma_f32_16x16x32_bf16 v[192:195], v[88:91], v[32:35], v[192:195]
    v_mfma_f32_16x16x32_bf16 v[196:199], v[88:91], v[36:39], v[196:199]
    v_mfma_f32_16x16x32_bf16 v[200:203], v[88:91], v[40:43], v[200:203]
    v_mfma_f32_16x16x32_bf16 v[204:207], v[88:91], v[44:47], v[204:207]
    buffer_load_dwordx4 v[88:91], v2, s[8:11], s56 offen offset:2048 sc1
    v_mfma_f32_16x16x32_bf16 v[208:211], v[92:95], v[32:35], v[208:211]
    v_mfma_f32_16x16x32_bf16 v[212:215], v[92:95], v[36:39], v[212:215]
    v_mfma_f32_16x16x32_bf16 v[216:219], v[92:95], v[40:43], v[216:219]
    v_mfma_f32_16x16x32_bf16 v[220:223], v[92:95], v[44:47], v[220:223]
    buffer_load_dwordx4 v[92:95], v2, s[8:11], s56 offen offset:3072 sc1
    s_waitcnt vmcnt(8)
    s_waitcnt lgkmcnt(4)
    v_mfma_f32_16x16x32_bf16 v[160:163], v[96:99], v[48:51], v[160:163]
    ds_read_b128 v[32:35], v9 offset:16384
    v_mfma_f32_16x16x32_bf16 v[164:167], v[96:99], v[52:55], v[164:167]
    ds_read_b128 v[36:39], v9 offset:17408
    v_mfma_f32_16x16x32_bf16 v[168:171], v[96:99], v[56:59], v[168:171]
    ds_read_b128 v[40:43], v9 offset:18432
    v_mfma_f32_16x16x32_bf16 v[172:175], v[96:99], v[60:63], v[172:175]
    ds_read_b128 v[44:47], v9 offset:19456
    s_add_u32 s56, s48, 32768
    buffer_load_dwordx4 v[96:99], v2, s[8:11], s56 offen offset:0 sc1
    v_mfma_f32_16x16x32_bf16 v[176:179], v[100:103], v[48:51], v[176:179]
    v_mfma_f32_16x16x32_bf16 v[180:183], v[100:103], v[52:55], v[180:183]
    v_mfma_f32_16x16x32_bf16 v[184:187], v[100:103], v[56:59], v[184:187]
    v_mfma_f32_16x16x32_bf16 v[188:191], v[100:103], v[60:63], v[188:191]
    buffer_load_dwordx4 v[100:103], v2, s[8:11], s56 offen offset:1024 sc1
    v_mfma_f32_16x16x32_bf16 v[192:195], v[104:107], v[48:51], v[192:195]
    v_mfma_f32_16x16x32_bf16 v[196:199], v[104:107], v[52:55], v[196:199]
    v_mfma_f32_16x16x32_bf16 v[200:203], v[104:107], v[56:59], v[200:203]
    v_mfma_f32_16x16x32_bf16 v[204:207], v[104:107], v[60:63], v[204:207]
    buffer_load_dwordx4 v[104:107], v2, s[8:11], s56 offen offset:2048 sc1
    v_mfma_f32_16x16x32_bf16 v[208:211], v[108:111], v[48:51], v[208:211]
    v_mfma_f32_16x16x32_bf16 v[212:215], v[108:111], v[52:55], v[212:215]
    v_mfma_f32_16x16x32_bf16 v[216:219], v[108:111], v[56:59], v[216:219]
    v_mfma_f32_16x16x32_bf16 v[220:223], v[108:111], v[60:63], v[220:223]
    buffer_load_dwordx4 v[108:111], v2, s[8:11], s56 offen offset:3072 sc1
    s_waitcnt vmcnt(8)
    s_waitcnt lgkmcnt(4)
    v_mfma_f32_16x16x32_bf16 v[160:163], v[64:67], v[16:19], v[160:163]
    ds_read_b128 v[48:51], v9 offset:20480
    v_mfma_f32_16x16x32_bf16 v[164:167], v[64:67], v[20:23], v[164:167]
    ds_read_b128 v[52:55], v9 offset:21504
    v_mfma_f32_16x16x32_bf16 v[168:171], v[64:67], v[24:27], v[168:171]
    ds_read_b128 v[56:59], v9 offset:22528
    v_mfma_f32_16x16x32_bf16 v[172:175], v[64:67], v[28:31], v[172:175]
    ds_read_b128 v[60:63], v9 offset:23552
    s_add_u32 s56, s48, 36864
    buffer_load_dwordx4 v[64:67], v2, s[8:11], s56 offen offset:0 sc1
    v_mfma_f32_16x16x32_bf16 v[176:179], v[68:71], v[16:19], v[176:179]
    v_mfma_f32_16x16x32_bf16 v[180:183], v[68:71], v[20:23], v[180:183]
    v_mfma_f32_16x16x32_bf16 v[184:187], v[68:71], v[24:27], v[184:187]
    v_mfma_f32_16x16x32_bf16 v[188:191], v[68:71], v[28:31], v[188:191]
    buffer_load_dwordx4 v[68:71], v2, s[8:11], s56 offen offset:1024 sc1
    v_mfma_f32_16x16x32_bf16 v[192:195], v[72:75], v[16:19], v[192:195]
    v_mfma_f32_16x16x32_bf16 v[196:199], v[72:75], v[20:23], v[196:199]
    v_mfma_f32_16x16x32_bf16 v[200:203], v[72:75], v[24:27], v[200:203]
    v_mfma_f32_16x16x32_bf16 v[204:207], v[72:75], v[28:31], v[204:207]
    buffer_load_dwordx4 v[72:75], v2, s[8:11], s56 offen offset:2048 sc1
    v_mfma_f32_16x16x32_bf16 v[208:211], v[76:79], v[16:19], v[208:211]
    v_mfma_f32_16x16x32_bf16 v[212:215], v[76:79], v[20:23], v[212:215]
    v_mfma_f32_16x16x32_bf16 v[216:219], v[76:79], v[24:27], v[216:219]
    v_mfma_f32_16x16x32_bf16 v[220:223], v[76:79], v[28:31], v[220:223]
    buffer_load_dwordx4 v[76:79], v2, s[8:11], s56 offen offset:3072 sc1
    s_waitcnt vmcnt(8)
    s_waitcnt lgkmcnt(4)
    v_mfma_f32_16x16x32_bf16 v[160:163], v[80:83], v[32:35], v[160:163]
    ds_read_b128 v[16:19], v9 offset:24576
    v_mfma_f32_16x16x32_bf16 v[164:167], v[80:83], v[36:39], v[164:167]
    ds_read_b128 v[20:23], v9 offset:25600
    v_mfma_f32_16x16x32_bf16 v[168:171], v[80:83], v[40:43], v[168:171]
    ds_read_b128 v[24:27], v9 offset:26624
    v_mfma_f32_16x16x32_bf16 v[172:175], v[80:83], v[44:47], v[172:175]
    ds_read_b128 v[28:31], v9 offset:27648
    v_mfma_f32_16x16x32_bf16 v[176:179], v[84:87], v[32:35], v[176:179]
    v_mfma_f32_16x16x32_bf16 v[180:183], v[84:87], v[36:39], v[180:183]
    v_mfma_f32_16x16x32_bf16 v[184:187], v[84:87], v[40:43], v[184:187]
    v_mfma_f32_16x16x32_bf16 v[188:191], v[84:87], v[44:47], v[188:191]
    v_mfma_f32_16x16x32_bf16 v[192:195], v[88:91], v[32:35], v[192:195]
    v_mfma_f32_16x16x32_bf16 v[196:199], v[88:91], v[36:39], v[196:199]
    v_mfma_f32_16x16x32_bf16 v[200:203], v[88:91], v[40:43], v[200:203]
    v_mfma_f32_16x16x32_bf16 v[204:207], v[88:91], v[44:47], v[204:207]
    v_mfma_f32_16x16x32_bf16 v[208:211], v[92:95], v[32:35], v[208:211]
    v_mfma_f32_16x16x32_bf16 v[212:215], v[92:95], v[36:39], v[212:215]
    v_mfma_f32_16x16x32_bf16 v[216:219], v[92:95], v[40:43], v[216:219]
    v_mfma_f32_16x16x32_bf16 v[220:223], v[92:95], v[44:47], v[220:223]
    s_waitcnt vmcnt(4)
    s_waitcnt lgkmcnt(4)
    v_mfma_f32_16x16x32_bf16 v[160:163], v[96:99], v[48:51], v[160:163]
    v_mfma_f32_16x16x32_bf16 v[164:167], v[96:99], v[52:55], v[164:167]
    v_mfma_f32_16x16x32_bf16 v[168:171], v[96:99], v[56:59], v[168:171]
    v_mfma_f32_16x16x32_bf16 v[172:175], v[96:99], v[60:63], v[172:175]
    v_mfma_f32_16x16x32_bf16 v[176:179], v[100:103], v[48:51], v[176:179]
    v_mfma_f32_16x16x32_bf16 v[180:183], v[100:103], v[52:55], v[180:183]
    v_mfma_f32_16x16x32_bf16 v[184:187], v[100:103], v[56:59], v[184:187]
    v_mfma_f32_16x16x32_bf16 v[188:191], v[100:103], v[60:63], v[188:191]
    v_mfma_f32_16x16x32_bf16 v[192:195], v[104:107], v[48:51], v[192:195]
    v_mfma_f32_16x16x32_bf16 v[196:199], v[104:107], v[52:55], v[196:199]
    v_mfma_f32_16x16x32_bf16 v[200:203], v[104:107], v[56:59], v[200:203]
    v_mfma_f32_16x16x32_bf16 v[204:207], v[104:107], v[60:63], v[204:207]
    v_mfma_f32_16x16x32_bf16 v[208:211], v[108:111], v[48:51], v[208:211]
    v_mfma_f32_16x16x32_bf16 v[212:215], v[108:111], v[52:55], v[212:215]
    v_mfma_f32_16x16x32_bf16 v[216:219], v[108:111], v[56:59], v[216:219]
    v_mfma_f32_16x16x32_bf16 v[220:223], v[108:111], v[60:63], v[220:223]
    s_waitcnt vmcnt(0)
    s_waitcnt lgkmcnt(0)
    v_mfma_f32_16x16x32_bf16 v[160:163], v[64:67], v[16:19], v[160:163]
    v_mfma_f32_16x16x32_bf16 v[164:167], v[64:67], v[20:23], v[164:167]
    v_mfma_f32_16x16x32_bf16 v[168:171], v[64:67], v[24:27], v[168:171]
    v_mfma_f32_16x16x32_bf16 v[172:175], v[64:67], v[28:31], v[172:175]
    v_mfma_f32_16x16x32_bf16 v[176:179], v[68:71], v[16:19], v[176:179]
    v_mfma_f32_16x16x32_bf16 v[180:183], v[68:71], v[20:23], v[180:183]
    v_mfma_f32_16x16x32_bf16 v[184:187], v[68:71], v[24:27], v[184:187]
    v_mfma_f32_16x16x32_bf16 v[188:191], v[68:71], v[28:31], v[188:191]
    v_mfma_f32_16x16x32_bf16 v[192:195], v[72:75], v[16:19], v[192:195]
    ds_write_b128 v9, v[160:163] offset:0
    ds_write_b128 v9, v[164:167] offset:1024
    v_mfma_f32_16x16x32_bf16 v[196:199], v[72:75], v[20:23], v[196:199]
    ds_write_b128 v11, v[168:171] offset:4096
    ds_write_b128 v11, v[172:175] offset:5120
    v_mfma_f32_16x16x32_bf16 v[200:203], v[72:75], v[24:27], v[200:203]
    ds_write_b128 v9, v[176:179] offset:2048
    ds_write_b128 v9, v[180:183] offset:3072
    v_mfma_f32_16x16x32_bf16 v[204:207], v[72:75], v[28:31], v[204:207]
    ds_write_b128 v11, v[184:187] offset:6144
    ds_write_b128 v11, v[188:191] offset:7168
    v_mfma_f32_16x16x32_bf16 v[208:211], v[76:79], v[16:19], v[208:211]
    ds_write_b128 v9, v[192:195] offset:8192
    ds_write_b128 v9, v[196:199] offset:9216
    v_mfma_f32_16x16x32_bf16 v[212:215], v[76:79], v[20:23], v[212:215]
    ds_write_b128 v11, v[200:203] offset:12288
    v_mfma_f32_16x16x32_bf16 v[216:219], v[76:79], v[24:27], v[216:219]
    ds_write_b128 v11, v[204:207] offset:13312
    v_mfma_f32_16x16x32_bf16 v[220:223], v[76:79], v[28:31], v[220:223]
    s_nop 0
    ds_write_b128 v9, v[208:211] offset:10240
    s_nop 1
    ds_write_b128 v9, v[212:215] offset:11264
    s_nop 0
    ds_write_b128 v11, v[216:219] offset:14336
    s_nop 0
    ds_write_b128 v11, v[220:223] offset:15360
    s_branch L_k2_final
L_p2_pq:
    s_load_dwordx2 s[6:7], s[0:1], 0
    s_load_dwordx4 s[44:47], s[0:1], 72
    s_mov_b32 s17, s54
    v_and_b32 v1, 63, v0
    v_lshlrev_b32 v2, 4, v1
    s_and_b32 s28, s2, 7
    s_lshr_b32 s31, s2, 3
    s_and_b32 s30, s31, 7
    s_and_b32 s29, s2, 6
    s_sub_u32 s22, 12, s29
    s_cmp_lt_u32 s2, 128
    s_cselect_b32 s29, s29, s22
    s_lshr_b32 s22, s2, 6
    s_add_u32 s29, s29, s22
    s_and_b32 s28, s28, 1
    s_lshr_b32 s18, s17, 2
    s_lshl_b32 s19, s28, 4
    s_add_u32 s19, s19, s29
    s_mov_b32 s8, s4
    s_mov_b32 s9, s5
    s_mov_b32 s10, 67108864
    s_mov_b32 s11, 0x20000
    s_lshl_b32 s61, s16, 2
    s_add_u32 s61, s61, 162576
    s_waitcnt lgkmcnt(0)
    s_setprio 0
    s_lshl_b32 s22, s28, 3
    s_add_u32 s22, s22, s30
    s_lshl_b32 s49, s22, 16
    s_lshr_b32 s22, s16, 1
    s_lshl_b32 s22, s22, 15
    s_add_u32 s49, s49, s22
    s_lshr_b32 s22, s22, 6
    s_lshl_b32 s58, s28, 10
    s_add_u32 s58, s58, s22
    s_add_u32 s58, s58, 14688256
    s_and_b32 s22, s16, 1
    s_lshl_b32 s22, s22, 11
    s_add_u32 s49, s49, s22
    s_add_u32 s49, s49, 12582912
    v_mov_b32 v100, 0
    v_mov_b32 v101, 0
    v_mov_b32 v102, 0
    v_mov_b32 v103, 0
    v_mov_b32 v104, 0
    v_mov_b32 v105, 0
    v_mov_b32 v106, 0
    v_mov_b32 v107, 0
    v_mov_b32 v108, 0
    v_mov_b32 v109, 0
    v_mov_b32 v110, 0
    v_mov_b32 v111, 0
    v_mov_b32 v112, 0
    v_mov_b32 v113, 0
    v_mov_b32 v114, 0
    v_mov_b32 v115, 0
    v_mov_b32 v116, 0
    v_mov_b32 v117, 0
    v_mov_b32 v118, 0
    v_mov_b32 v119, 0
    v_mov_b32 v120, 0
    v_mov_b32 v121, 0
    v_mov_b32 v122, 0
    v_mov_b32 v123, 0
    v_mov_b32 v124, 0
    v_mov_b32 v125, 0
    v_mov_b32 v126, 0
    v_mov_b32 v127, 0
    v_mov_b32 v128, 0
    v_mov_b32 v129, 0
    v_mov_b32 v130, 0
    v_mov_b32 v131, 0
    v_mov_b32 v32, 0xbf803f80
    v_mov_b32 v33, 0xbf803f80
    v_mov_b32 v34, 0xbf803f80
    v_mov_b32 v35, 0xbf803f80
    s_and_b32 s60, s2, 15
    s_lshr_b32 s22, s2, 6
    s_lshl_b32 s22, s22, 4
    s_or_b32 s60, s60, s22
    s_and_b32 s60, s60, 31
    s_lshl_b32 s60, s60, 2
    s_lshr_b32 s22, s30, 1
    s_add_u32 s60, s60, s22
    s_lshl_b32 s60, s60, 1
    s_lshl_b32 s60, s60, 7
    s_add_u32 s60, s60, 15794176
    v_lshlrev_b32 v11, 2, v1
    s_cmp_lg_u32 s16, 0
    s_cbranch_scc1 L_p2_p0
    buffer_load_dword v12, v11, s[8:11], s60 offen sc1
L_p2_p0:
    s_mov_b32 s24, s6
    s_mov_b32 s25, s7
    s_mov_b32 s26, 2097152
    s_mov_b32 s27, 0x20000
    s_mov_b32 s36, s46
    s_mov_b32 s37, s47
    s_mov_b32 s38, 2097152
    s_mov_b32 s39, 0x20000
    s_mov_b32 s32, s44
    s_mov_b32 s33, s45
    s_mov_b32 s34, 1024
    s_mov_b32 s35, 0x20000
    v_and_b32 v3, 15, v1
    v_lshrrev_b32 v4, 4, v1
    s_lshl_b32 s22, s29, 6
    s_add_u32 s22, s22, s28
    s_lshl_b32 s23, s18, 5
    s_add_u32 s22, s22, s23
    v_lshl_add_u32 v5, v4, 3, s22
    s_lshr_b32 s22, s16, 1
    s_cmp_eq_u32 s22, 0
    s_cselect_b32 s50, 1, -1
    s_cselect_b32 s51, 0, 2097152
    s_lshl_b32 s50, s50, 10
    s_lshl_b32 s22, s30, 5
    v_add_u32 v6, s22, v3
    s_and_b32 s22, s16, 1
    s_cmp_eq_u32 s22, 0
    s_cselect_b32 s52, 2, -2
    s_cselect_b32 s53, 0, 1024
    v_mov_b32 v7, s53
    v_mad_i32_i24 v182, v6, s52, v7
    v_add_u32 v6, 16, v6
    v_mad_i32_i24 v183, v6, s52, v7
    v_cmp_eq_u32 vcc, 1024, v182
    v_mov_b32 v7, 512
    v_mov_b32 v8, s51
    v_cndmask_b32 v182, v182, v7, vcc
    v_add_u32 v6, 0, v5
    v_mad_i32_i24 v6, v6, s50, v8
    v_cmp_eq_u32 vcc, 2097152, v6
    v_mov_b32 v7, 1048576
    s_nop 0
    v_cndmask_b32 v6, v6, v7, vcc
    v_add_u32 v172, v6, v182
    v_add_u32 v176, v6, v183
    v_add_u32 v6, 2, v5
    v_mad_i32_i24 v6, v6, s50, v8
    v_add_u32 v173, v6, v182
    v_add_u32 v177, v6, v183
    v_add_u32 v6, 4, v5
    v_mad_i32_i24 v6, v6, s50, v8
    v_add_u32 v174, v6, v182
    v_add_u32 v178, v6, v183
    v_add_u32 v6, 6, v5
    v_mad_i32_i24 v6, v6, s50, v8
    v_add_u32 v175, v6, v182
    v_add_u32 v179, v6, v183
    buffer_load_ushort v164, v172, s[24:27], 0 offen
    buffer_load_ushort v165, v173, s[24:27], 0 offen
    buffer_load_ushort v166, v174, s[24:27], 0 offen
    buffer_load_ushort v167, v175, s[24:27], 0 offen
    buffer_load_ushort v168, v176, s[24:27], 0 offen
    buffer_load_ushort v169, v177, s[24:27], 0 offen
    buffer_load_ushort v170, v178, s[24:27], 0 offen
    buffer_load_ushort v171, v179, s[24:27], 0 offen
    buffer_load_ushort v180, v182, s[32:35], 0 offen
    buffer_load_ushort v181, v183, s[32:35], 0 offen
    v_lshlrev_b32 v7, 2, v1
    s_cmp_lg_u32 s16, 0
    s_cbranch_scc1 L_p2_pl
    s_waitcnt vmcnt(10)
    v_cmp_ne_u32 vcc, s63, v12
    s_cbranch_vccz L_pa_q
    s_mov_b64 exec, -1
    s_mov_b32 s23, 0x10000
L_pa_p:
    buffer_load_dword v12, v7, s[8:11], s60 offen sc1
L_pa_t:
    s_sub_u32 s23, s23, 1
    s_waitcnt vmcnt(0)
    v_cmp_ne_u32 vcc, s63, v12
    s_cbranch_vccz L_pa_q
    s_cmp_eq_u32 s23, 0
    s_cbranch_scc1 L_pa_q
    s_sleep 4
    s_branch L_pa_p
L_pa_q:
    s_mov_b64 exec, -1
    v_mov_b32 v3, 162568
    v_mov_b32 v4, 1
    ds_write_b32 v3, v4
    s_branch L_p2_pg
L_p2_pl:
    v_mov_b32 v3, 162568
    s_mov_b32 s23, 0x100000
L_pa_w:
    ds_read_b32 v4, v3
    s_sub_u32 s23, s23, 1
    s_waitcnt lgkmcnt(0)
    v_cmp_ne_u32 vcc, 0, v4
    s_cbranch_vccnz L_pa_x
    s_cmp_eq_u32 s23, 0
    s_cbranch_scc1 L_pa_x
    s_sleep 1
    s_branch L_pa_w
L_pa_x:
L_p2_pg:
    s_setprio 2
    s_cmp_lg_u32 s16, 0
    s_cbranch_scc1 L_p2_nr
    s_lshl_b32 s22, s28, 10
    s_lshl_b32 s23, s30, 7
    s_add_u32 s22, s22, s23
    s_add_u32 s22, s22, 14680064
    s_mov_b32 s23, 14681088
    v_and_b32 v3, 15, v1
    v_lshlrev_b32 v3, 2, v3
    v_mov_b32 v4, 0
    buffer_load_dword v8, v3, s[8:11], s22 offen sc1
    buffer_load_dword v9, v3, s[8:11], s22 offen offset:64 sc1
    buffer_load_dword v10, v4, s[8:11], s23 offen sc1
L_p2_nr:
    s_and_b32 s22, s16, 1
    s_or_b32 s22, s22, s30
    s_cmp_lg_u32 s22, 0
    s_cbranch_scc1 L_p2_nb
    v_and_b32 v11, 7, v1
    v_lshlrev_b32 v11, 6, v11
    v_and_b32 v12, 48, v1
    v_add_u32 v11, v11, v12
    buffer_load_dwordx4 v[132:135], v11, s[8:11], s58 offen sc1
L_p2_nb:
    s_add_u32 s57, s49, 0
    buffer_load_dwordx4 v[36:39], v2, s[8:11], s57 offen offset:0 sc1
    buffer_load_dwordx4 v[40:43], v2, s[8:11], s57 offen offset:1024 sc1
    s_add_u32 s57, s49, 4096
    buffer_load_dwordx4 v[44:47], v2, s[8:11], s57 offen offset:0 sc1
    buffer_load_dwordx4 v[48:51], v2, s[8:11], s57 offen offset:1024 sc1
    s_add_u32 s57, s49, 8192
    buffer_load_dwordx4 v[52:55], v2, s[8:11], s57 offen offset:0 sc1
    buffer_load_dwordx4 v[56:59], v2, s[8:11], s57 offen offset:1024 sc1
    s_add_u32 s57, s49, 12288
    buffer_load_dwordx4 v[60:63], v2, s[8:11], s57 offen offset:0 sc1
    buffer_load_dwordx4 v[64:67], v2, s[8:11], s57 offen offset:1024 sc1
    s_add_u32 s57, s49, 16384
    buffer_load_dwordx4 v[68:71], v2, s[8:11], s57 offen offset:0 sc1
    buffer_load_dwordx4 v[72:75], v2, s[8:11], s57 offen offset:1024 sc1
    s_add_u32 s57, s49, 20480
    buffer_load_dwordx4 v[76:79], v2, s[8:11], s57 offen offset:0 sc1
    buffer_load_dwordx4 v[80:83], v2, s[8:11], s57 offen offset:1024 sc1
    s_add_u32 s57, s49, 24576
    buffer_load_dwordx4 v[84:87], v2, s[8:11], s57 offen offset:0 sc1
    buffer_load_dwordx4 v[88:91], v2, s[8:11], s57 offen offset:1024 sc1
    s_add_u32 s57, s49, 28672
    buffer_load_dwordx4 v[92:95], v2, s[8:11], s57 offen offset:0 sc1
    buffer_load_dwordx4 v[96:99], v2, s[8:11], s57 offen offset:1024 sc1
    s_setprio 2
    s_and_b32 s22, s16, 1
    s_or_b32 s22, s22, s30
    s_cmp_lg_u32 s22, 0
    s_cbranch_scc1 L_p2_nx
    s_waitcnt vmcnt(16)
    v_mov_b32_dpp v136, v132 row_shl:1 row_mask:0xf bank_mask:0xf bound_ctrl:0
    v_mov_b32_dpp v137, v133 row_shl:1 row_mask:0xf bank_mask:0xf bound_ctrl:0
    v_mov_b32_dpp v138, v134 row_shl:1 row_mask:0xf bank_mask:0xf bound_ctrl:0
    v_mov_b32_dpp v139, v135 row_shl:1 row_mask:0xf bank_mask:0xf bound_ctrl:0
    v_mov_b32_dpp v140, v132 row_shl:2 row_mask:0xf bank_mask:0xf bound_ctrl:0
    v_mov_b32_dpp v141, v133 row_shl:2 row_mask:0xf bank_mask:0xf bound_ctrl:0
    v_mov_b32_dpp v142, v134 row_shl:2 row_mask:0xf bank_mask:0xf bound_ctrl:0
    v_mov_b32_dpp v143, v135 row_shl:2 row_mask:0xf bank_mask:0xf bound_ctrl:0
    v_mov_b32_dpp v144, v132 row_shl:3 row_mask:0xf bank_mask:0xf bound_ctrl:0
    v_mov_b32_dpp v145, v133 row_shl:3 row_mask:0xf bank_mask:0xf bound_ctrl:0
    v_mov_b32_dpp v146, v134 row_shl:3 row_mask:0xf bank_mask:0xf bound_ctrl:0
    v_mov_b32_dpp v147, v135 row_shl:3 row_mask:0xf bank_mask:0xf bound_ctrl:0
    v_mov_b32_dpp v148, v132 row_shl:4 row_mask:0xf bank_mask:0xf bound_ctrl:0
    v_mov_b32_dpp v149, v133 row_shl:4 row_mask:0xf bank_mask:0xf bound_ctrl:0
    v_mov_b32_dpp v150, v134 row_shl:4 row_mask:0xf bank_mask:0xf bound_ctrl:0
    v_mov_b32_dpp v151, v135 row_shl:4 row_mask:0xf bank_mask:0xf bound_ctrl:0
    v_mov_b32_dpp v152, v132 row_shl:5 row_mask:0xf bank_mask:0xf bound_ctrl:0
    v_mov_b32_dpp v153, v133 row_shl:5 row_mask:0xf bank_mask:0xf bound_ctrl:0
    v_mov_b32_dpp v154, v134 row_shl:5 row_mask:0xf bank_mask:0xf bound_ctrl:0
    v_mov_b32_dpp v155, v135 row_shl:5 row_mask:0xf bank_mask:0xf bound_ctrl:0
    v_mov_b32_dpp v156, v132 row_shl:6 row_mask:0xf bank_mask:0xf bound_ctrl:0
    v_mov_b32_dpp v157, v133 row_shl:6 row_mask:0xf bank_mask:0xf bound_ctrl:0
    v_mov_b32_dpp v158, v134 row_shl:6 row_mask:0xf bank_mask:0xf bound_ctrl:0
    v_mov_b32_dpp v159, v135 row_shl:6 row_mask:0xf bank_mask:0xf bound_ctrl:0
    v_mov_b32_dpp v160, v132 row_shl:7 row_mask:0xf bank_mask:0xf bound_ctrl:0
    v_mov_b32_dpp v161, v133 row_shl:7 row_mask:0xf bank_mask:0xf bound_ctrl:0
    v_mov_b32_dpp v162, v134 row_shl:7 row_mask:0xf bank_mask:0xf bound_ctrl:0
    v_mov_b32_dpp v163, v135 row_shl:7 row_mask:0xf bank_mask:0xf bound_ctrl:0
    s_nop 1
    v_mfma_f32_16x16x32_bf16 v[116:119], v[192:195], v[132:135], v[116:119]
    v_mfma_f32_16x16x32_bf16 v[120:123], v[196:199], v[132:135], v[120:123]
    v_mfma_f32_16x16x32_bf16 v[116:119], v[200:203], v[136:139], v[116:119]
    v_mfma_f32_16x16x32_bf16 v[120:123], v[204:207], v[136:139], v[120:123]
    v_mfma_f32_16x16x32_bf16 v[116:119], v[208:211], v[140:143], v[116:119]
    v_mfma_f32_16x16x32_bf16 v[120:123], v[212:215], v[140:143], v[120:123]
    v_mfma_f32_16x16x32_bf16 v[116:119], v[216:219], v[144:147], v[116:119]
    v_mfma_f32_16x16x32_bf16 v[120:123], v[220:223], v[144:147], v[120:123]
    v_mfma_f32_16x16x32_bf16 v[116:119], v[224:227], v[148:151], v[116:119]
    v_mfma_f32_16x16x32_bf16 v[120:123], v[228:231], v[148:151], v[120:123]
    v_mfma_f32_16x16x32_bf16 v[116:119], v[232:235], v[152:155], v[116:119]
    v_mfma_f32_16x16x32_bf16 v[120:123], v[236:239], v[152:155], v[120:123]
    v_mfma_f32_16x16x32_bf16 v[116:119], v[240:243], v[156:159], v[116:119]
    v_mfma_f32_16x16x32_bf16 v[120:123], v[244:247], v[156:159], v[120:123]
    v_mfma_f32_16x16x32_bf16 v[116:119], v[248:251], v[160:163], v[116:119]
    v_mfma_f32_16x16x32_bf16 v[120:123], v[252:255], v[160:163], v[120:123]
L_p2_nx:
    s_waitcnt vmcnt(14)
    v_swap_b32 v38, v40
    v_swap_b32 v39, v41
    s_nop 1
    v_mfma_f32_16x16x32_bf16 v[100:103], v[192:195], v[36:39], v[100:103]
    v_mfma_f32_16x16x32_bf16 v[104:107], v[192:195], v[40:43], v[104:107]
    v_mfma_f32_16x16x32_bf16 v[108:111], v[196:199], v[36:39], v[108:111]
    v_mfma_f32_16x16x32_bf16 v[112:115], v[196:199], v[40:43], v[112:115]
    v_mfma_f32_16x16x32_bf16 v[124:127], v[32:35], v[36:39], v[124:127]
    v_mfma_f32_16x16x32_bf16 v[128:131], v[32:35], v[40:43], v[128:131]
    s_waitcnt vmcnt(12)
    v_swap_b32 v46, v48
    v_swap_b32 v47, v49
    s_nop 1
    v_mfma_f32_16x16x32_bf16 v[100:103], v[200:203], v[44:47], v[100:103]
    v_mfma_f32_16x16x32_bf16 v[104:107], v[200:203], v[48:51], v[104:107]
    v_mfma_f32_16x16x32_bf16 v[108:111], v[204:207], v[44:47], v[108:111]
    v_mfma_f32_16x16x32_bf16 v[112:115], v[204:207], v[48:51], v[112:115]
    v_mfma_f32_16x16x32_bf16 v[124:127], v[32:35], v[44:47], v[124:127]
    v_mfma_f32_16x16x32_bf16 v[128:131], v[32:35], v[48:51], v[128:131]
    s_waitcnt vmcnt(10)
    v_swap_b32 v54, v56
    v_swap_b32 v55, v57
    s_nop 1
    v_mfma_f32_16x16x32_bf16 v[100:103], v[208:211], v[52:55], v[100:103]
    v_mfma_f32_16x16x32_bf16 v[104:107], v[208:211], v[56:59], v[104:107]
    v_mfma_f32_16x16x32_bf16 v[108:111], v[212:215], v[52:55], v[108:111]
    v_mfma_f32_16x16x32_bf16 v[112:115], v[212:215], v[56:59], v[112:115]
    v_mfma_f32_16x16x32_bf16 v[124:127], v[32:35], v[52:55], v[124:127]
    v_mfma_f32_16x16x32_bf16 v[128:131], v[32:35], v[56:59], v[128:131]
    s_waitcnt vmcnt(8)
    v_swap_b32 v62, v64
    v_swap_b32 v63, v65
    s_nop 1
    v_mfma_f32_16x16x32_bf16 v[100:103], v[216:219], v[60:63], v[100:103]
    v_mfma_f32_16x16x32_bf16 v[104:107], v[216:219], v[64:67], v[104:107]
    v_mfma_f32_16x16x32_bf16 v[108:111], v[220:223], v[60:63], v[108:111]
    v_mfma_f32_16x16x32_bf16 v[112:115], v[220:223], v[64:67], v[112:115]
    v_mfma_f32_16x16x32_bf16 v[124:127], v[32:35], v[60:63], v[124:127]
    v_mfma_f32_16x16x32_bf16 v[128:131], v[32:35], v[64:67], v[128:131]
    s_waitcnt vmcnt(6)
    v_swap_b32 v70, v72
    v_swap_b32 v71, v73
    s_nop 1
    v_mfma_f32_16x16x32_bf16 v[100:103], v[224:227], v[68:71], v[100:103]
    v_mfma_f32_16x16x32_bf16 v[104:107], v[224:227], v[72:75], v[104:107]
    v_mfma_f32_16x16x32_bf16 v[108:111], v[228:231], v[68:71], v[108:111]
    v_mfma_f32_16x16x32_bf16 v[112:115], v[228:231], v[72:75], v[112:115]
    v_mfma_f32_16x16x32_bf16 v[124:127], v[32:35], v[68:71], v[124:127]
    v_mfma_f32_16x16x32_bf16 v[128:131], v[32:35], v[72:75], v[128:131]
    s_waitcnt vmcnt(4)
    v_swap_b32 v78, v80
    v_swap_b32 v79, v81
    s_nop 1
    v_mfma_f32_16x16x32_bf16 v[100:103], v[232:235], v[76:79], v[100:103]
    v_mfma_f32_16x16x32_bf16 v[104:107], v[232:235], v[80:83], v[104:107]
    v_mfma_f32_16x16x32_bf16 v[108:111], v[236:239], v[76:79], v[108:111]
    v_mfma_f32_16x16x32_bf16 v[112:115], v[236:239], v[80:83], v[112:115]
    v_mfma_f32_16x16x32_bf16 v[124:127], v[32:35], v[76:79], v[124:127]
    v_mfma_f32_16x16x32_bf16 v[128:131], v[32:35], v[80:83], v[128:131]
    s_waitcnt vmcnt(2)
    v_swap_b32 v86, v88
    v_swap_b32 v87, v89
    s_nop 1
    v_mfma_f32_16x16x32_bf16 v[100:103], v[240:243], v[84:87], v[100:103]
    v_mfma_f32_16x16x32_bf16 v[104:107], v[240:243], v[88:91], v[104:107]
    v_mfma_f32_16x16x32_bf16 v[108:111], v[244:247], v[84:87], v[108:111]
    v_mfma_f32_16x16x32_bf16 v[112:115], v[244:247], v[88:91], v[112:115]
    v_mfma_f32_16x16x32_bf16 v[124:127], v[32:35], v[84:87], v[124:127]
    v_mfma_f32_16x16x32_bf16 v[128:131], v[32:35], v[88:91], v[128:131]
    s_waitcnt vmcnt(0)
    v_swap_b32 v94, v96
    v_swap_b32 v95, v97
    s_nop 1
    v_mfma_f32_16x16x32_bf16 v[100:103], v[248:251], v[92:95], v[100:103]
    v_mfma_f32_16x16x32_bf16 v[104:107], v[248:251], v[96:99], v[104:107]
    v_mfma_f32_16x16x32_bf16 v[108:111], v[252:255], v[92:95], v[108:111]
    v_mfma_f32_16x16x32_bf16 v[112:115], v[252:255], v[96:99], v[112:115]
    v_mfma_f32_16x16x32_bf16 v[124:127], v[32:35], v[92:95], v[124:127]
    v_mfma_f32_16x16x32_bf16 v[128:131], v[32:35], v[96:99], v[128:131]
    s_lshl_b32 s22, s16, 12
    s_add_u32 s22, s22, 135168
    v_add_u32 v13, s22, v2
    s_lshr_b32 s22, s16, 1
    s_lshl_b32 s23, s22, 11
    s_add_u32 s23, s23, 151552
    v_add_u32 v14, s23, v2
    s_lshl_b32 s23, s22, 10
    s_add_u32 s23, s23, 159744
    v_add_u32 v15, s23, v2
    s_nop 7
    ds_write_b128 v13, v[100:103] offset:0
    ds_write_b128 v13, v[104:107] offset:1024
    ds_write_b128 v13, v[108:111] offset:2048
    ds_write_b128 v13, v[112:115] offset:3072
    s_bitcmp1_b32 s16, 0
    s_cbranch_scc1 L_p2_x3
    ds_write_b128 v14, v[116:119] offset:0
    ds_write_b128 v14, v[124:127] offset:4096
    ds_write_b128 v14, v[120:123] offset:1024
    ds_write_b128 v14, v[128:131] offset:5120
    s_cmp_lg_u32 s16, 0
    s_cbranch_scc1 L_p2_xe
    v_add_u32 v3, 161792, v7
    ds_write_b32 v3, v8 offset:0
    ds_write_b32 v3, v9 offset:256
    ds_write_b32 v3, v10 offset:512
    s_branch L_p2_xe
L_p2_x3:
    ds_write_b128 v15, v[124:127]
L_p2_xe:
    s_waitcnt lgkmcnt(0)
    v_mov_b32 v3, 162560
    v_mov_b32 v4, 1
    s_mov_b64 exec, 1
    ds_add_u32 v3, v4
    s_mov_b64 exec, -1
    s_cmp_eq_u32 s28, 0
    s_cselect_b32 s51, 1.0, -1.0
    s_cselect_b32 s53, 1.0, 0
    s_lshl_b32 s22, s16, 10
    s_add_u32 s22, s22, 135168
    v_add_u32 v8, s22, v2
    v_lshl_add_u32 v5, v1, 3, s22
    s_and_b32 s50, s16, 1
    s_lshl_b32 s22, s50, 8
    s_add_u32 s22, s22, 161792
    v_lshl_add_u32 v9, v1, 2, s22
    s_lshr_b32 s22, s16, 1
    s_lshl_b32 s22, s22, 10
    s_add_u32 s22, s22, 151552
    v_add_u32 v7, s22, v2
    s_or_b32 s50, s50, s30
    s_lshr_b32 s22, s16, 1
    s_or_b32 s49, s22, s19
    v_mov_b32 v3, 162560
    s_mov_b32 s23, 0x100000
L_pq_w:
    ds_read_b32 v4, v3
    s_sub_u32 s23, s23, 1
    s_waitcnt lgkmcnt(0)
    v_cmp_eq_u32 vcc, 4, v4
    s_cbranch_vccnz L_pq_x
    s_cmp_eq_u32 s23, 0
    s_cbranch_scc1 L_pq_x
    s_sleep 1
    s_branch L_pq_w
L_pq_x:
    ds_read_b32 v116, v9
    ds_read_b128 v[40:43], v8
    ds_read_b128 v[96:99], v8 offset:8192
    ds_read_b128 v[48:51], v8 offset:4096
    ds_read_b128 v[104:107], v8 offset:12288
    s_waitcnt lgkmcnt(2)
    v_mul_f32 v80, s51, v116
    v_pk_add_f32 v[40:41], v[40:41], v[96:97]
    v_pk_add_f32 v[42:43], v[42:43], v[98:99]
    s_waitcnt lgkmcnt(0)
    v_pk_add_f32 v[48:49], v[48:49], v[104:105]
    v_pk_add_f32 v[50:51], v[50:51], v[106:107]
    v_sub_f32 v120, v40, v48
    v_add_f32 v124, v40, v48
    v_sub_f32 v121, v41, v49
    v_add_f32 v125, v41, v49
    v_sub_f32 v122, v42, v50
    v_add_f32 v126, v42, v50
    v_sub_f32 v123, v43, v51
    v_add_f32 v127, v43, v51
    v_add_f32 v132, v120, v116
    v_add_f32 v128, v124, v80
    v_add_f32 v120, v120, v116
    v_add_f32 v124, v124, v80
    v_sub_f32 v133, v121, v116
    v_sub_f32 v129, v125, v80
    v_sub_f32 v121, v121, v116
    v_sub_f32 v125, v125, v80
    v_add_f32 v134, v122, v116
    v_add_f32 v130, v126, v80
    v_add_f32 v122, v122, v116
    v_add_f32 v126, v126, v80
    v_sub_f32 v135, v123, v116
    v_sub_f32 v131, v127, v80
    v_sub_f32 v123, v123, v116
    v_sub_f32 v127, v127, v80
    s_cmp_lg_u32 s50, 0
    s_cbranch_scc1 L_k2_n0
    ds_read_b32 v118, v9 offset:512
    ds_read_b128 v[56:59], v7
    ds_read_b128 v[112:115], v7 offset:2048
    s_mov_b32 s22, 0x00010001
    s_mov_b32 s23, 0x00010001
    v_mul_f32 v82, s53, v116
    s_waitcnt lgkmcnt(0)
    v_mul_f32 v83, s53, v118
    s_mov_b64 exec, s[22:23]
    v_add_f32 v56, v56, v112
    v_add_f32 v120, v40, v82
    v_add_f32 v128, v40, v82
    v_add_f32 v124, v56, v83
    v_add_f32 v132, v56, v83
    v_add_f32 v57, v57, v113
    v_sub_f32 v121, v41, v82
    v_sub_f32 v129, v41, v82
    v_sub_f32 v125, v57, v83
    v_sub_f32 v133, v57, v83
    v_add_f32 v58, v58, v114
    v_add_f32 v122, v42, v82
    v_add_f32 v130, v42, v82
    v_add_f32 v126, v58, v83
    v_add_f32 v134, v58, v83
    v_add_f32 v59, v59, v115
    v_sub_f32 v123, v43, v82
    v_sub_f32 v131, v43, v82
    v_sub_f32 v127, v59, v83
    v_sub_f32 v135, v59, v83
    s_mov_b64 exec, -1
L_k2_n0:
    s_cmp_lg_u32 s49, 0
    s_cbranch_scc1 L_k2_c0
    ds_read_b32 v60, v8 offset:20480
    ds_read_b32 v61, v8 offset:22528
    ds_read_b32 v68, v7 offset:8192
    ds_read_b32 v69, v7 offset:9216
    s_waitcnt lgkmcnt(0)
    s_mov_b64 exec, 0xffff
    v_add_f32 v60, v60, v61
    v_add_f32 v68, v68, v69
    v_add_f32 v128, v60, v116
    v_add_f32 v132, v60, v116
    s_cmp_eq_u32 s50, 0
    s_cselect_b32 s22, 1, 0
    s_mov_b32 s23, 0
    s_mov_b64 exec, s[22:23]
    v_add_f32 v132, v68, v118
    s_mov_b64 exec, -1
L_k2_c0:
    v_cvt_pk_bf16_f32 v120, v120, v121
    v_cvt_pk_bf16_f32 v121, v122, v123
    ds_write_b64 v5, v[120:121] offset:0
    v_cvt_pk_bf16_f32 v124, v124, v125
    v_cvt_pk_bf16_f32 v125, v126, v127
    ds_write_b64 v5, v[124:125] offset:4096
    v_cvt_pk_bf16_f32 v128, v128, v129
    v_cvt_pk_bf16_f32 v129, v130, v131
    ds_write_b64 v5, v[128:129] offset:8192
    v_cvt_pk_bf16_f32 v132, v132, v133
    v_cvt_pk_bf16_f32 v133, v134, v135
    ds_write_b64 v5, v[132:133] offset:12288
    s_lshl_b32 s22, s16, 12
    v_add_u32 v3, s22, v2
    v_add_u32 v10, 65536, v3
    s_add_u32 s22, s22, 135168
    v_lshl_add_u32 v5, v1, 3, s22
    s_mov_b32 s52, 0xbfb8aa3b
    s_waitcnt vmcnt(0)
    s_mov_b32 s50, 1.0
    s_mov_b32 s51, 1.0
    s_movk_i32 s53, 0x3f80
    v_lshlrev_b32 v136, 16, v180
    v_mov_b32 v144, 0
    v_lshlrev_b32 v137, 16, v180
    v_mov_b32 v145, 0
    v_lshlrev_b32 v138, 16, v180
    v_mov_b32 v146, 0
    v_lshlrev_b32 v139, 16, v180
    v_mov_b32 v147, 0
    v_lshlrev_b32 v140, 16, v181
    v_mov_b32 v148, 0
    v_lshlrev_b32 v141, 16, v181
    v_mov_b32 v149, 0
    v_lshlrev_b32 v142, 16, v181
    v_mov_b32 v150, 0
    v_lshlrev_b32 v143, 16, v181
    v_mov_b32 v151, 0
    v_lshlrev_b32 v224, 16, v164
    v_lshlrev_b32 v225, 16, v165
    v_lshlrev_b32 v226, 16, v166
    v_lshlrev_b32 v227, 16, v167
    v_lshlrev_b32 v228, 16, v168
    v_lshlrev_b32 v229, 16, v169
    v_lshlrev_b32 v230, 16, v170
    v_lshlrev_b32 v231, 16, v171
    v_mov_b32 v232, v172
    v_mov_b32 v233, v173
    v_mov_b32 v234, v174
    v_mov_b32 v235, v175
    v_mov_b32 v236, v176
    v_mov_b32 v237, v177
    v_mov_b32 v238, v178
    v_mov_b32 v239, v179
L_k2_final:
    s_waitcnt lgkmcnt(0)
    s_barrier
    ds_read2_b64 v[12:15], v5 offset0:0 offset1:128
    ds_read_b128 v[16:19], v3 offset:0
    ds_read_b128 v[20:23], v3 offset:1024
    ds_read_b128 v[24:27], v3 offset:32768
    ds_read_b128 v[28:31], v3 offset:33792
    ds_read_b128 v[32:35], v10 offset:0
    ds_read_b128 v[36:39], v10 offset:1024
    ds_read_b128 v[88:91], v10 offset:32768
    ds_read_b128 v[92:95], v10 offset:33792
    s_waitcnt lgkmcnt(4)
    v_pk_add_f32 v[16:17], v[16:17], v[24:25]
    v_pk_add_f32 v[18:19], v[18:19], v[26:27]
    v_pk_add_f32 v[20:21], v[20:21], v[28:29]
    v_pk_add_f32 v[22:23], v[22:23], v[30:31]
    v_and_b32 v48, 0xffff, v12
    v_and_b32 v49, 0xffff0000, v12
    v_and_b32 v50, 0xffff, v13
    v_and_b32 v51, 0xffff0000, v13
    v_and_b32 v52, 0xffff, v14
    v_and_b32 v53, 0xffff0000, v14
    v_and_b32 v54, 0xffff, v15
    v_and_b32 v55, 0xffff0000, v15
    s_waitcnt lgkmcnt(0)
    v_pk_add_f32 v[32:33], v[32:33], v[88:89]
    v_pk_add_f32 v[34:35], v[34:35], v[90:91]
    v_pk_add_f32 v[36:37], v[36:37], v[92:93]
    v_pk_add_f32 v[38:39], v[38:39], v[94:95]
    v_pk_add_f32 v[16:17], v[16:17], v[32:33]
    v_pk_add_f32 v[18:19], v[18:19], v[34:35]
    v_pk_add_f32 v[20:21], v[20:21], v[36:37]
    v_pk_add_f32 v[22:23], v[22:23], v[38:39]
    v_cvt_pk_bf16_f32 v24, v16, v17
    v_cvt_pk_bf16_f32 v25, v18, v19
    v_cvt_pk_bf16_f32 v26, v20, v21
    v_cvt_pk_bf16_f32 v27, v22, v23
    v_dot2c_f32_bf16 v136, s53, v24
    v_dot2c_f32_bf16 v137, s50, v24
    v_dot2c_f32_bf16 v138, s53, v25
    v_dot2c_f32_bf16 v139, s50, v25
    v_dot2c_f32_bf16 v140, s53, v26
    v_dot2c_f32_bf16 v141, s50, v26
    v_dot2c_f32_bf16 v142, s53, v27
    v_dot2c_f32_bf16 v143, s50, v27
    v_cvt_pk_bf16_f32 v24, v136, v137
    v_cvt_pk_bf16_f32 v25, v138, v139
    v_cvt_pk_bf16_f32 v26, v140, v141
    v_cvt_pk_bf16_f32 v27, v142, v143
    v_lshlrev_b32 v16, 16, v24
    v_and_b32 v17, 0xffff0000, v24
    v_lshlrev_b32 v18, 16, v25
    v_and_b32 v19, 0xffff0000, v25
    v_lshlrev_b32 v20, 16, v26
    v_and_b32 v21, 0xffff0000, v26
    v_lshlrev_b32 v22, 16, v27
    v_and_b32 v23, 0xffff0000, v27
    v_pk_mul_f32 v[72:73], v[16:17], s[52:53] op_sel_hi:[1,0]
    v_pk_mul_f32 v[74:75], v[18:19], s[52:53] op_sel_hi:[1,0]
    v_pk_mul_f32 v[76:77], v[20:21], s[52:53] op_sel_hi:[1,0]
    v_pk_mul_f32 v[78:79], v[22:23], s[52:53] op_sel_hi:[1,0]
    v_exp_f32 v72, v72
    v_exp_f32 v73, v73
    v_exp_f32 v74, v74
    v_exp_f32 v75, v75
    v_exp_f32 v76, v76
    v_exp_f32 v77, v77
    v_exp_f32 v78, v78
    v_exp_f32 v79, v79
    v_pk_add_f32 v[72:73], v[72:73], s[50:51]
    v_pk_add_f32 v[74:75], v[74:75], s[50:51]
    v_pk_add_f32 v[76:77], v[76:77], s[50:51]
    v_pk_add_f32 v[78:79], v[78:79], s[50:51]
    v_rcp_f32 v72, v72
    v_rcp_f32 v73, v73
    v_rcp_f32 v74, v74
    v_rcp_f32 v75, v75
    v_rcp_f32 v76, v76
    v_rcp_f32 v77, v77
    v_rcp_f32 v78, v78
    v_rcp_f32 v79, v79
    v_pk_mul_f32 v[16:17], v[72:73], v[16:17]
    v_pk_mul_f32 v[18:19], v[74:75], v[18:19]
    v_pk_mul_f32 v[20:21], v[76:77], v[20:21]
    v_pk_mul_f32 v[22:23], v[78:79], v[22:23]
    v_cvt_pk_bf16_f32 v24, v16, v17
    v_cvt_pk_bf16_f32 v25, v18, v19
    v_cvt_pk_bf16_f32 v26, v20, v21
    v_cvt_pk_bf16_f32 v27, v22, v23
    v_dot2c_f32_bf16 v144, v48, v24
    v_dot2c_f32_bf16 v145, v49, v24
    v_dot2c_f32_bf16 v146, v50, v25
    v_dot2c_f32_bf16 v147, v51, v25
    v_dot2c_f32_bf16 v148, v52, v26
    v_dot2c_f32_bf16 v149, v53, v26
    v_dot2c_f32_bf16 v150, v54, v27
    v_dot2c_f32_bf16 v151, v55, v27
    v_cvt_pk_bf16_f32 v24, v144, v145
    v_cvt_pk_bf16_f32 v25, v146, v147
    v_cvt_pk_bf16_f32 v26, v148, v149
    v_cvt_pk_bf16_f32 v27, v150, v151
    v_dot2c_f32_bf16 v224, s53, v24
    v_dot2c_f32_bf16 v225, s50, v24
    v_dot2c_f32_bf16 v226, s53, v25
    v_dot2c_f32_bf16 v227, s50, v25
    v_dot2c_f32_bf16 v228, s53, v26
    v_dot2c_f32_bf16 v229, s50, v26
    v_dot2c_f32_bf16 v230, s53, v27
    v_dot2c_f32_bf16 v231, s50, v27
    v_cvt_pk_bf16_f32 v72, v224, v225
    buffer_store_short v72, v232, s[36:39], 0 offen
    buffer_store_short_d16_hi v72, v233, s[36:39], 0 offen
    v_cvt_pk_bf16_f32 v74, v226, v227
    buffer_store_short v74, v234, s[36:39], 0 offen
    buffer_store_short_d16_hi v74, v235, s[36:39], 0 offen
    v_cvt_pk_bf16_f32 v76, v228, v229
    buffer_store_short v76, v236, s[36:39], 0 offen
    buffer_store_short_d16_hi v76, v237, s[36:39], 0 offen
    v_cvt_pk_bf16_f32 v78, v230, v231
    buffer_store_short v78, v238, s[36:39], 0 offen
    buffer_store_short_d16_hi v78, v239, s[36:39], 0 offen
L_k1_done:
    s_endpgm
.section .rodata,"a"
.p2align 6
.amdhsa_kernel recurrent_scan__spectral_fnet__mixer_channel_mlp__prompt_kernel
  .amdhsa_next_free_vgpr 256
  .amdhsa_next_free_sgpr 102
  .amdhsa_accum_offset 256
  .amdhsa_group_segment_fixed_size 0
  .amdhsa_kernarg_size 104
  .amdhsa_user_sgpr_count 2
  .amdhsa_user_sgpr_kernarg_segment_ptr 1
  .amdhsa_system_sgpr_workgroup_id_x 1
.end_amdhsa_kernel
```
